```python
import torch

def _softmax(x, axis=-1):
    return torch.softmax(x, dim=axis)
def _gelu(x):
    return torch.nn.functional.gelu(x, approximate="tanh")
def _silu(x):
    return torch.nn.functional.silu(x)
def _sigmoid(x):
    return torch.sigmoid(x)
def _layernorm(x, axis=-1, eps=1e-5):
    m = x.mean(dim=axis, keepdim=True)
    v = x.var(dim=axis, keepdim=True, unbiased=False)
    return (x - m) / torch.sqrt(v + eps)
def _scatter_add(tgt, idx, src, axis=0):
    return tgt.clone().index_add_(axis, idx, src)
def _segment_sum(src, seg, n):
    out = torch.zeros((n,) + src.shape[1:], dtype=src.dtype)
    return out.index_add_(0, seg, src)
def _pad(x, pw):
    flat = tuple(v for pair in reversed(pw) for v in pair)
    return torch.nn.functional.pad(x, flat)

kernel_name = 'concat_heads__ssm_conv_s4d__ssm_conv_s5__prompt'

def setup_inputs():

    _w = (lambda a: (lambda t: t.to(torch.bfloat16) if t.is_floating_point() else t)(torch.as_tensor(a)))
    def _A_setup():
        Bsz, L, D, N = 1, 2048, 576, 128
        return {
            "u": _w((lambda *s: torch.randn(*s, dtype=torch.bfloat16) * 0.05)(Bsz, L, D)),
            "log_A_real": _w((lambda *s: torch.randn(*s, dtype=torch.bfloat16) * 3.2)(D, N) * 0.5),
            "A_imag": _w((lambda *s: torch.randn(*s, dtype=torch.bfloat16) * 0.05)(D, N) * 3.14),
            "C_real": _w((lambda *s: torch.randn(*s, dtype=torch.bfloat16) * 0.1)(D, N) / N ** 0.5),
            "C_imag": _w((lambda *s: torch.randn(*s, dtype=torch.bfloat16) * 0.1)(D, N) / N ** 0.5),
            "log_dt": _w((lambda *s: torch.randn(*s, dtype=torch.bfloat16) * 0.05)(D) * 0.5 - 4.0),
            "D_skip": _w((lambda *s: torch.randn(*s, dtype=torch.bfloat16) * 0.05)(D)),
        }
    _A_in = _A_setup()

    def _B_setup():
        B, S, D = 1, 2048, 576
        P = D
        Lambda_re = -0.5 * (lambda _x: torch.exp(torch.as_tensor(_x)))((lambda *s: torch.randn(*s, dtype=torch.bfloat16) * 0.2)(P))
        Lambda_im = (lambda *s: torch.randn(*s, dtype=torch.bfloat16) * 0.4)(P) * 1.0
        B_re = (lambda *s: torch.randn(*s, dtype=torch.bfloat16) * 0.2)(P, D) * (D ** -0.5)
        B_im = (lambda *s: torch.randn(*s, dtype=torch.bfloat16) * 0.2)(P, D) * (D ** -0.5)
        C_re = (lambda *s: torch.randn(*s, dtype=torch.bfloat16) * 0.2)(D, P) * (P ** -0.5)
        C_im = (lambda *s: torch.randn(*s, dtype=torch.bfloat16) * 0.2)(D, P) * (P ** -0.5)
        log_dt = (lambda *s: torch.randn(*s, dtype=torch.bfloat16) * 0.2)(P) * 0.3 - 2.0
        Dskip = (lambda *s: torch.randn(*s, dtype=torch.bfloat16) * 0.05)(D)
        return {
            "x": _w((lambda *s: torch.randn(*s, dtype=torch.bfloat16) * 0.05)(B, S, D)),
            "Lambda_re": _w(Lambda_re),
            "Lambda_im": _w(Lambda_im),
            "B_re": _w(B_re),
            "B_im": _w(B_im),
            "C_re": _w(C_re),
            "C_im": _w(C_im),
            "log_dt": _w(log_dt),
            "Dskip": _w(Dskip),
        }
    _B_in = _B_setup()

    return {
        "A_u": _A_in["u"],
        "A_log_A_real": _A_in["log_A_real"],
        "A_A_imag": _A_in["A_imag"],
        "A_C_real": _A_in["C_real"],
        "A_C_imag": _A_in["C_imag"],
        "A_log_dt": _A_in["log_dt"],
        "A_D_skip": _A_in["D_skip"],
        "B_x": _B_in["x"],
        "B_Lambda_re": _B_in["Lambda_re"],
        "B_Lambda_im": _B_in["Lambda_im"],
        "B_B_re": _B_in["B_re"],
        "B_B_im": _B_in["B_im"],
        "B_C_re": _B_in["C_re"],
        "B_C_im": _B_in["C_im"],
        "B_log_dt": _B_in["log_dt"],
        "B_Dskip": _B_in["Dskip"],
    }

def reference(A_u, A_log_A_real, A_A_imag, A_C_real, A_C_imag, A_log_dt, A_D_skip, B_x, B_Lambda_re, B_Lambda_im, B_B_re, B_B_im, B_C_re, B_C_im, B_log_dt, B_Dskip):
    def _A_ref(u, log_A_real, A_imag, C_real, C_imag, log_dt, D_skip):
        L = u.shape[1]
        dt = torch.exp(log_dt)
        A = -torch.exp(log_A_real) + 1j * A_imag
        C = (C_real + 1j * C_imag) * dt[:, None]
        pos = (lambda x, dt: x.to(dt))(torch.arange(L), log_dt.dtype)
        P = torch.exp((A * dt[:, None])[:, :, None] * pos[None, None, :])
        K = 2.0 * torch.einsum("dn,dnl->dl", C, P).real
        L2 = 2 * L
        u_t = (lambda x, *d: x.permute(*d))(u, 0, 2, 1)
        Kf = (lambda x, *a, **k: torch.fft.rfft(x.float(), *a, **k))(K, L2)
        Uf = (lambda x, *a, **k: torch.fft.rfft(x.float(), *a, **k))(u_t, L2)
        y = (lambda x, *a, **k: torch.fft.irfft(x, *a, **k).to(torch.bfloat16))(Uf * Kf[None, :, :], L2)[:, :, :L]
        y = (lambda x, *d: x.permute(*d))(y, 0, 2, 1)
        return y + u * D_skip[None, None, :]

    def _B_ref(x, Lambda_re, Lambda_im, B_re, B_im, C_re, C_im, log_dt, Dskip):
        Bsz, L, H = x.shape
        Lam = Lambda_re + 1j * Lambda_im
        Bmat = B_re + 1j * B_im
        Cmat = C_re + 1j * C_im
        dt = torch.exp(log_dt)
        Lam_bar = torch.exp(dt * Lam)
        B_bar = ((Lam_bar - 1.0) / Lam)[:, None] * Bmat
        Bu = torch.einsum("bld,pd->blp", x + 0j, B_bar)
        h = torch.zeros_like(Bu[:, 0, :])
        hs = []
        for t in range(L):
            h = Lam_bar[None, :] * h + Bu[:, t, :]
            hs.append(h)
        hseq = torch.stack(hs, 1)
        y = 2.0 * torch.einsum("blp,dp->bld", hseq, Cmat).real + x * Dskip[None, None, :]
        return y

    a = _A_ref(A_u, A_log_A_real, A_A_imag, A_C_real, A_C_imag, A_log_dt, A_D_skip)
    b = _B_ref(B_x, B_Lambda_re, B_Lambda_im, B_B_re, B_B_im, B_C_re, B_C_im, B_log_dt, B_Dskip)
    return torch.concatenate([a, b], axis=-1)
```

```asm
; @launch grid=(254,1,1) block=(512,1,1) lds=163840
.amdgcn_target "amdgcn-amd-amdhsa--gfx950"
.text
.globl concat_heads__ssm_conv_s4d__ssm_conv_s5__prompt_kernel
.p2align 8
.type concat_heads__ssm_conv_s4d__ssm_conv_s5__prompt_kernel,@function
concat_heads__ssm_conv_s4d__ssm_conv_s5__prompt_kernel:
    s_cmp_ge_u32 s2, 254
    s_cbranch_scc1 L_end
    s_load_dwordx16 s[16:31], s[0:1], 0
    s_load_dwordx16 s[32:47], s[0:1], 64
    s_load_dwordx4 s[48:51], s[0:1], 128
    s_load_dwordx2 s[52:53], s[0:1], 144
    v_lshrrev_b32 v1, 6, v0
    v_and_b32 v0, 63, v0
    v_readfirstlane_b32 s3, v1
    s_cmp_ge_u32 s2, 144
    s_cbranch_scc1 L_A
L_B:
    s_lshr_b32 s6, s2, 3
    s_and_b32 s9, s2, 7
    s_lshl_b32 s4, s9, 1
    s_cmp_ge_u32 s6, 9
    s_cselect_b32 s8, 1, 0
    s_add_u32 s4, s4, s8
    s_mul_i32 s9, s8, 9
    s_sub_u32 s5, s6, s9
    s_lshl_b32 s9, s8, 2
    s_add_u32 s7, s5, s9
    s_cmp_ge_u32 s7, 9
    s_cselect_b32 s9, 9, 0
    s_sub_u32 s7, s7, s9
    s_cmp_lt_u32 s3, 4
    s_cbranch_scc1 L_B_comp
L_B_dma:
    s_setprio 3
    v_lshrrev_b32 v4, 3, v0
    v_and_b32 v5, 7, v0
    v_lshrrev_b32 v6, 1, v4
    v_xor_b32 v6, v6, v5
    v_lshlrev_b32 v6, 4, v6
    v_xor_b32 v7, 64, v6
    s_lshl_b32 s11, s7, 7
    s_and_b32 s9, s3, 1
    s_lshl_b32 s12, s9, 13
    s_cmp_le_u32 s3, 5
    s_cbranch_scc1 L_B_dmax
    v_mul_u32_u24 v8, 4608, v4
    v_add_u32 v1, v8, v6
    v_add_u32 v2, v8, v7
    v_add_u32 v2, 36864, v2
    s_mul_i32 s8, s5, 73728
    s_movk_i32 s72, 1152
    s_movk_i32 s73, 1152
    s_add_u32 s13, s12, 16384
    s_waitcnt lgkmcnt(0)
    s_cmp_eq_u32 s9, 0
    s_cselect_b32 s56, s36, s38
    s_cselect_b32 s57, s37, s39
    s_mov_b32 s58, 0xa2000
    s_mov_b32 s59, 0x20000
    s_branch L_B_dmago
L_B_dmax:
    v_lshrrev_b32 v8, 2, v4
    v_lshlrev_b32 v8, 3, v8
    v_and_b32 v9, 1, v4
    v_lshl_add_u32 v8, v9, 2, v8
    v_bfe_u32 v9, v4, 1, 1
    v_add_u32 v8, v8, v9
    v_mul_u32_u24 v8, 1152, v8
    v_add_u32 v1, v8, v6
    v_add_u32 v2, v8, v7
    v_add_u32 v2, 18432, v2
    s_lshl_b32 s8, s4, 1
    s_add_u32 s8, s8, s9
    s_mul_i32 s8, s8, 73728
    s_movk_i32 s72, 2304
    s_mov_b32 s73, 34560
    s_mov_b32 s13, s12
    s_waitcnt lgkmcnt(0)
    s_mov_b32 s56, s30
    s_mov_b32 s57, s31
    s_mov_b32 s58, 0x240000
    s_mov_b32 s59, 0x20000
L_B_dmago:
    s_mov_b32 s14, 0
L_ring:
    s_add_u32 m0, s13, 0
    s_add_u32 s10, s11, s8
    buffer_load_dwordx4 v1, s[56:59], s10 offen lds
    s_add_u32 m0, s13, 1024
    s_nop 0
    buffer_load_dwordx4 v2, s[56:59], s10 offen lds
    s_add_u32 m0, s13, 2048
    s_add_u32 s10, s10, s72
    buffer_load_dwordx4 v1, s[56:59], s10 offen lds
    s_add_u32 m0, s13, 3072
    s_nop 0
    buffer_load_dwordx4 v2, s[56:59], s10 offen lds
    s_add_u32 m0, s13, 4096
    s_add_u32 s10, s10, s73
    buffer_load_dwordx4 v1, s[56:59], s10 offen lds
    s_add_u32 m0, s13, 5120
    s_nop 0
    buffer_load_dwordx4 v2, s[56:59], s10 offen lds
    s_add_u32 m0, s13, 6144
    s_add_u32 s10, s10, s72
    buffer_load_dwordx4 v1, s[56:59], s10 offen lds
    s_add_u32 m0, s13, 7168
    s_nop 0
    buffer_load_dwordx4 v2, s[56:59], s10 offen lds
    s_add_u32 s11, s11, 128
    s_cmp_eq_u32 s11, 1152
    s_cselect_b32 s11, 0, s11
    s_add_u32 s13, s13, 32768
    s_and_b32 s13, s13, 0x1ffff
    s_add_u32 s14, s14, 1
    s_cmp_lt_u32 s14, 3
    s_cbranch_scc1 L_ring
    s_waitcnt vmcnt(16)
    s_barrier
    s_cmp_lt_u32 s14, 9
    s_cbranch_scc1 L_ring
    s_cmp_ge_u32 s3, 6
    s_cbranch_scc1 L_cw
    s_cmp_eq_u32 s3, 5
    s_cbranch_scc1 L_w5
    s_mov_b32 s72, s50
    s_mov_b32 s73, s51
    s_mov_b32 s74, 0x100
    s_mov_b32 s75, 0x20000
    v_mov_b32 v51, 0
    buffer_load_dword v52, v51, s[72:75], 0 offen sc1
    s_waitcnt vmcnt(9)
    s_barrier
    s_waitcnt vmcnt(0)
    s_barrier
    s_mov_b32 s6, 200000
L_tag:
    v_cmp_ne_u32 vcc, 0, v52
    s_cbranch_vccnz L_B_scan
    buffer_load_dword v52, v51, s[72:75], 0 offen sc1
    s_waitcnt vmcnt(0)
    s_sub_u32 s6, s6, 1
    s_cbranch_scc0 L_tag
    v_mov_b32 v52, 1
    s_branch L_B_scan
L_w5:
    s_waitcnt vmcnt(8)
    s_barrier
    s_waitcnt vmcnt(0)
    s_barrier
    s_branch L_c_done
L_cw:
    s_waitcnt vmcnt(8)
    s_barrier
    s_cmp_eq_u32 s9, 0
    s_cselect_b32 s56, s40, s42
    s_cselect_b32 s57, s41, s43
    s_mov_b32 s58, 0xa2000
    s_mov_b32 s59, 0x20000
    s_lshl_b32 s11, s5, 7
    s_add_u32 m0, s12, 131072
    s_add_u32 s10, s11, s8
    buffer_load_dwordx4 v1, s[56:59], s10 offen lds
    s_add_u32 m0, s12, 132096
    s_nop 0
    buffer_load_dwordx4 v2, s[56:59], s10 offen lds
    s_add_u32 m0, s12, 133120
    s_add_u32 s10, s10, 1152
    buffer_load_dwordx4 v1, s[56:59], s10 offen lds
    s_add_u32 m0, s12, 134144
    s_nop 0
    buffer_load_dwordx4 v2, s[56:59], s10 offen lds
    s_add_u32 m0, s12, 135168
    s_add_u32 s10, s10, 1152
    buffer_load_dwordx4 v1, s[56:59], s10 offen lds
    s_add_u32 m0, s12, 136192
    s_nop 0
    buffer_load_dwordx4 v2, s[56:59], s10 offen lds
    s_add_u32 m0, s12, 137216
    s_add_u32 s10, s10, 1152
    buffer_load_dwordx4 v1, s[56:59], s10 offen lds
    s_add_u32 m0, s12, 138240
    s_nop 0
    buffer_load_dwordx4 v2, s[56:59], s10 offen lds
    s_add_u32 s11, s11, 128
    s_cmp_eq_u32 s11, 1152
    s_cselect_b32 s11, 0, s11
    s_waitcnt vmcnt(8)
    s_barrier
    v_mov_b32 v20, 159232
    s_waitcnt vmcnt(0)
    v_mov_b32 v21, 1
    s_mov_b64 exec, 1
    ds_add_u32 v20, v21 offset:16
    s_mov_b64 exec, -1
L_wait5:
    ds_read_b32 v21, v20 offset:8
    s_waitcnt lgkmcnt(0)
    v_cmp_eq_u32 vcc, 0, v21
    s_cbranch_vccnz L_wait5
    s_add_u32 m0, s12, 32768
    s_add_u32 s10, s11, s8
    buffer_load_dwordx4 v1, s[56:59], s10 offen lds
    s_add_u32 m0, s12, 33792
    s_nop 0
    buffer_load_dwordx4 v2, s[56:59], s10 offen lds
    s_add_u32 m0, s12, 34816
    s_add_u32 s10, s10, 1152
    buffer_load_dwordx4 v1, s[56:59], s10 offen lds
    s_add_u32 m0, s12, 35840
    s_nop 0
    buffer_load_dwordx4 v2, s[56:59], s10 offen lds
    s_add_u32 m0, s12, 36864
    s_add_u32 s10, s10, 1152
    buffer_load_dwordx4 v1, s[56:59], s10 offen lds
    s_add_u32 m0, s12, 37888
    s_nop 0
    buffer_load_dwordx4 v2, s[56:59], s10 offen lds
    s_add_u32 m0, s12, 38912
    s_add_u32 s10, s10, 1152
    buffer_load_dwordx4 v1, s[56:59], s10 offen lds
    s_add_u32 m0, s12, 39936
    s_nop 0
    buffer_load_dwordx4 v2, s[56:59], s10 offen lds
    s_add_u32 s11, s11, 128
    s_cmp_eq_u32 s11, 1152
    s_cselect_b32 s11, 0, s11
    s_add_u32 m0, s12, 49152
    s_add_u32 s10, s11, s8
    buffer_load_dwordx4 v1, s[56:59], s10 offen lds
    s_add_u32 m0, s12, 50176
    s_nop 0
    buffer_load_dwordx4 v2, s[56:59], s10 offen lds
    s_add_u32 m0, s12, 51200
    s_add_u32 s10, s10, 1152
    buffer_load_dwordx4 v1, s[56:59], s10 offen lds
    s_add_u32 m0, s12, 52224
    s_nop 0
    buffer_load_dwordx4 v2, s[56:59], s10 offen lds
    s_add_u32 m0, s12, 53248
    s_add_u32 s10, s10, 1152
    buffer_load_dwordx4 v1, s[56:59], s10 offen lds
    s_add_u32 m0, s12, 54272
    s_nop 0
    buffer_load_dwordx4 v2, s[56:59], s10 offen lds
    s_add_u32 m0, s12, 55296
    s_add_u32 s10, s10, 1152
    buffer_load_dwordx4 v1, s[56:59], s10 offen lds
    s_add_u32 m0, s12, 56320
    s_nop 0
    buffer_load_dwordx4 v2, s[56:59], s10 offen lds
    s_add_u32 s11, s11, 128
    s_cmp_eq_u32 s11, 1152
    s_cselect_b32 s11, 0, s11
    s_add_u32 m0, s12, 65536
    s_add_u32 s10, s11, s8
    buffer_load_dwordx4 v1, s[56:59], s10 offen lds
    s_add_u32 m0, s12, 66560
    s_nop 0
    buffer_load_dwordx4 v2, s[56:59], s10 offen lds
    s_add_u32 m0, s12, 67584
    s_add_u32 s10, s10, 1152
    buffer_load_dwordx4 v1, s[56:59], s10 offen lds
    s_add_u32 m0, s12, 68608
    s_nop 0
    buffer_load_dwordx4 v2, s[56:59], s10 offen lds
    s_add_u32 m0, s12, 69632
    s_add_u32 s10, s10, 1152
    buffer_load_dwordx4 v1, s[56:59], s10 offen lds
    s_add_u32 m0, s12, 70656
    s_nop 0
    buffer_load_dwordx4 v2, s[56:59], s10 offen lds
    s_add_u32 m0, s12, 71680
    s_add_u32 s10, s10, 1152
    buffer_load_dwordx4 v1, s[56:59], s10 offen lds
    s_add_u32 m0, s12, 72704
    s_nop 0
    buffer_load_dwordx4 v2, s[56:59], s10 offen lds
    s_add_u32 s11, s11, 128
    s_cmp_eq_u32 s11, 1152
    s_cselect_b32 s11, 0, s11
    s_add_u32 m0, s12, 81920
    s_add_u32 s10, s11, s8
    buffer_load_dwordx4 v1, s[56:59], s10 offen lds
    s_add_u32 m0, s12, 82944
    s_nop 0
    buffer_load_dwordx4 v2, s[56:59], s10 offen lds
    s_add_u32 m0, s12, 83968
    s_add_u32 s10, s10, 1152
    buffer_load_dwordx4 v1, s[56:59], s10 offen lds
    s_add_u32 m0, s12, 84992
    s_nop 0
    buffer_load_dwordx4 v2, s[56:59], s10 offen lds
    s_add_u32 m0, s12, 86016
    s_add_u32 s10, s10, 1152
    buffer_load_dwordx4 v1, s[56:59], s10 offen lds
    s_add_u32 m0, s12, 87040
    s_nop 0
    buffer_load_dwordx4 v2, s[56:59], s10 offen lds
    s_add_u32 m0, s12, 88064
    s_add_u32 s10, s10, 1152
    buffer_load_dwordx4 v1, s[56:59], s10 offen lds
    s_add_u32 m0, s12, 89088
    s_nop 0
    buffer_load_dwordx4 v2, s[56:59], s10 offen lds
    s_add_u32 s11, s11, 128
    s_cmp_eq_u32 s11, 1152
    s_cselect_b32 s11, 0, s11
    s_add_u32 m0, s12, 98304
    s_add_u32 s10, s11, s8
    buffer_load_dwordx4 v1, s[56:59], s10 offen lds
    s_add_u32 m0, s12, 99328
    s_nop 0
    buffer_load_dwordx4 v2, s[56:59], s10 offen lds
    s_add_u32 m0, s12, 100352
    s_add_u32 s10, s10, 1152
    buffer_load_dwordx4 v1, s[56:59], s10 offen lds
    s_add_u32 m0, s12, 101376
    s_nop 0
    buffer_load_dwordx4 v2, s[56:59], s10 offen lds
    s_add_u32 m0, s12, 102400
    s_add_u32 s10, s10, 1152
    buffer_load_dwordx4 v1, s[56:59], s10 offen lds
    s_add_u32 m0, s12, 103424
    s_nop 0
    buffer_load_dwordx4 v2, s[56:59], s10 offen lds
    s_add_u32 m0, s12, 104448
    s_add_u32 s10, s10, 1152
    buffer_load_dwordx4 v1, s[56:59], s10 offen lds
    s_add_u32 m0, s12, 105472
    s_nop 0
    buffer_load_dwordx4 v2, s[56:59], s10 offen lds
    s_add_u32 s11, s11, 128
    s_cmp_eq_u32 s11, 1152
    s_cselect_b32 s11, 0, s11
L_wait10:
    ds_read_b32 v21, v20 offset:4
    s_waitcnt lgkmcnt(0)
    v_cmp_ne_u32 vcc, 4, v21
    s_cbranch_vccnz L_wait10
    s_add_u32 m0, s12, 114688
    s_add_u32 s10, s11, s8
    buffer_load_dwordx4 v1, s[56:59], s10 offen lds
    s_add_u32 m0, s12, 115712
    s_nop 0
    buffer_load_dwordx4 v2, s[56:59], s10 offen lds
    s_add_u32 m0, s12, 116736
    s_add_u32 s10, s10, 1152
    buffer_load_dwordx4 v1, s[56:59], s10 offen lds
    s_add_u32 m0, s12, 117760
    s_nop 0
    buffer_load_dwordx4 v2, s[56:59], s10 offen lds
    s_add_u32 m0, s12, 118784
    s_add_u32 s10, s10, 1152
    buffer_load_dwordx4 v1, s[56:59], s10 offen lds
    s_add_u32 m0, s12, 119808
    s_nop 0
    buffer_load_dwordx4 v2, s[56:59], s10 offen lds
    s_add_u32 m0, s12, 120832
    s_add_u32 s10, s10, 1152
    buffer_load_dwordx4 v1, s[56:59], s10 offen lds
    s_add_u32 m0, s12, 121856
    s_nop 0
    buffer_load_dwordx4 v2, s[56:59], s10 offen lds
    s_add_u32 s11, s11, 128
    s_cmp_eq_u32 s11, 1152
    s_cselect_b32 s11, 0, s11
L_wait4:
    ds_read_b32 v21, v20 offset:12
    s_waitcnt lgkmcnt(0)
    v_cmp_ne_u32 vcc, 4, v21
    s_cbranch_vccnz L_wait4
    s_waitcnt vmcnt(47)
    s_add_u32 m0, s12, 0
    s_add_u32 s10, s11, s8
    buffer_load_dwordx4 v1, s[56:59], s10 offen lds
    s_add_u32 m0, s12, 1024
    s_nop 0
    buffer_load_dwordx4 v2, s[56:59], s10 offen lds
    s_add_u32 m0, s12, 2048
    s_add_u32 s10, s10, 1152
    buffer_load_dwordx4 v1, s[56:59], s10 offen lds
    s_add_u32 m0, s12, 3072
    s_nop 0
    buffer_load_dwordx4 v2, s[56:59], s10 offen lds
    s_add_u32 m0, s12, 4096
    s_add_u32 s10, s10, 1152
    buffer_load_dwordx4 v1, s[56:59], s10 offen lds
    s_add_u32 m0, s12, 5120
    s_nop 0
    buffer_load_dwordx4 v2, s[56:59], s10 offen lds
    s_add_u32 m0, s12, 6144
    s_add_u32 s10, s10, 1152
    buffer_load_dwordx4 v1, s[56:59], s10 offen lds
    s_add_u32 m0, s12, 7168
    s_nop 0
    buffer_load_dwordx4 v2, s[56:59], s10 offen lds
    s_add_u32 s11, s11, 128
    s_cmp_eq_u32 s11, 1152
    s_cselect_b32 s11, 0, s11
    s_add_u32 m0, s12, 16384
    s_add_u32 s10, s11, s8
    buffer_load_dwordx4 v1, s[56:59], s10 offen lds
    s_add_u32 m0, s12, 17408
    s_nop 0
    buffer_load_dwordx4 v2, s[56:59], s10 offen lds
    s_add_u32 m0, s12, 18432
    s_add_u32 s10, s10, 1152
    buffer_load_dwordx4 v1, s[56:59], s10 offen lds
    s_add_u32 m0, s12, 19456
    s_nop 0
    buffer_load_dwordx4 v2, s[56:59], s10 offen lds
    s_add_u32 m0, s12, 20480
    s_add_u32 s10, s10, 1152
    buffer_load_dwordx4 v1, s[56:59], s10 offen lds
    s_add_u32 m0, s12, 21504
    s_nop 0
    buffer_load_dwordx4 v2, s[56:59], s10 offen lds
    s_add_u32 m0, s12, 22528
    s_add_u32 s10, s10, 1152
    buffer_load_dwordx4 v1, s[56:59], s10 offen lds
    s_add_u32 m0, s12, 23552
    s_nop 0
    buffer_load_dwordx4 v2, s[56:59], s10 offen lds
    s_add_u32 s11, s11, 128
    s_cmp_eq_u32 s11, 1152
    s_cselect_b32 s11, 0, s11
L_c_done:
    s_setprio 0
    v_and_b32 v4, 15, v0
    v_lshrrev_b32 v5, 4, v0
    v_lshrrev_b32 v6, 1, v4
    v_xor_b32 v6, v6, v5
    v_lshlrev_b32 v6, 4, v6
    v_lshl_add_u32 v248, v4, 7, v6
    s_sub_u32 s11, s3, 4
    s_lshl_b32 s8, s4, 7
    s_lshl_b32 s9, s11, 5
    s_add_u32 s10, s8, s9
    v_lshl_add_u32 v6, v5, 3, s10
    v_add_u32 v6, 4, v6
    v_mul_u32_u24 v3, 4608, v6
    v_lshl_add_u32 v3, v4, 4, v3
    s_lshl_b32 s8, s4, 2
    s_add_u32 s8, s8, s11
    s_mul_i32 s12, s8, 73856
    s_add_u32 s13, s12, 36864
    s_lshl_b32 s8, s5, 12
    s_add_u32 s14, s12, s8
    s_add_u32 s15, s13, s8
    v_lshlrev_b32 v1, 4, v0
    v_add_u32 v1, 36864, v1
    v_mov_b32 v216, 0
    v_mov_b32 v217, 0
    v_mov_b32 v218, 0
    v_mov_b32 v219, 0
    v_mov_b32 v220, 0
    v_mov_b32 v221, 0
    v_mov_b32 v222, 0
    v_mov_b32 v223, 0
    v_mov_b32 v224, 0
    v_mov_b32 v225, 0
    v_mov_b32 v226, 0
    v_mov_b32 v227, 0
    v_mov_b32 v228, 0
    v_mov_b32 v229, 0
    v_mov_b32 v230, 0
    v_mov_b32 v231, 0
    s_mov_b32 s60, s52
    s_mov_b32 s61, s53
    s_mov_b32 s62, 0x10000000
    s_mov_b32 s63, 0x20000
    s_mov_b32 s64, s48
    s_mov_b32 s65, s49
    s_mov_b32 s66, 0x900000
    s_mov_b32 s67, 0x20000
    s_waitcnt vmcnt(0)
    s_branch L_B_g2
L_B_scan:
    s_mov_b32 s60, s52
    s_mov_b32 s61, s53
    s_mov_b32 s62, 0x10000000
    s_mov_b32 s63, 0x20000
    v_lshlrev_b32 v3, 3, v0
    v_add_u32 v3, 147456, v3
    ds_read_b64 v[58:59], v3 offset:15360
    v_mov_b32 v96, 0
    v_mov_b32 v97, 0
    v_mov_b32 v100, 0
    v_mov_b32 v101, 0
    v_mov_b32 v104, 0
    v_mov_b32 v105, 0
    v_mov_b32 v108, 0
    v_mov_b32 v109, 0
    v_mov_b32 v112, 0
    v_mov_b32 v113, 0
    v_mov_b32 v116, 0
    v_mov_b32 v117, 0
    v_mov_b32 v120, 0
    v_mov_b32 v121, 0
    v_mov_b32 v124, 0
    v_mov_b32 v125, 0
    v_mov_b32 v128, 0
    v_mov_b32 v129, 0
    v_mov_b32 v132, 0
    v_mov_b32 v133, 0
    v_mov_b32 v136, 0
    v_mov_b32 v137, 0
    v_mov_b32 v140, 0
    v_mov_b32 v141, 0
    v_mov_b32 v144, 0
    v_mov_b32 v145, 0
    v_mov_b32 v148, 0
    v_mov_b32 v149, 0
    v_mov_b32 v152, 0
    v_mov_b32 v153, 0
    v_lshlrev_b32 v1, 4, v0
    s_lshl_b32 s8, s5, 14
    s_lshl_b32 s10, s4, 10
    s_add_u32 s8, s8, s10
    s_add_u32 s8, s8, 0x500000
    s_lshl_b32 s79, s4, 11
    s_add_u32 s79, s79, 0x540000
    v_lshlrev_b32 v8, 7, v0
    s_waitcnt lgkmcnt(0)
    v_mov_b32 v53, v52
    v_mov_b32 v98, v52
    v_mov_b32 v102, v52
    v_mov_b32 v106, v52
    v_mov_b32 v110, v52
    v_mov_b32 v114, v52
    v_mov_b32 v118, v52
    v_mov_b32 v122, v52
    v_mov_b32 v126, v52
    v_mov_b32 v130, v52
    v_mov_b32 v134, v52
    v_mov_b32 v138, v52
    v_mov_b32 v142, v52
    v_mov_b32 v146, v52
    v_mov_b32 v150, v52
    v_mov_b32 v154, v52
    v_pk_mul_f32 v[60:61], v[58:59], v[58:59] op_sel:[0,0] op_sel_hi:[1,0]
    v_pk_fma_f32 v[60:61], v[58:59], v[58:59], v[60:61] op_sel:[1,1,0] op_sel_hi:[0,1,1] neg_lo:[1,0,0]
    v_pk_mul_f32 v[62:63], v[60:61], v[58:59] op_sel:[0,0] op_sel_hi:[1,0]
    v_pk_fma_f32 v[62:63], v[60:61], v[58:59], v[62:63] op_sel:[1,1,0] op_sel_hi:[0,1,1] neg_lo:[1,0,0]
    v_pk_mul_f32 v[64:65], v[60:61], v[60:61] op_sel:[0,0] op_sel_hi:[1,0]
    v_pk_fma_f32 v[64:65], v[60:61], v[60:61], v[64:65] op_sel:[1,1,0] op_sel_hi:[0,1,1] neg_lo:[1,0,0]
    v_pk_mul_f32 v[72:73], v[64:65], v[64:65] op_sel:[0,0] op_sel_hi:[1,0]
    v_pk_fma_f32 v[72:73], v[64:65], v[64:65], v[72:73] op_sel:[1,1,0] op_sel_hi:[0,1,1] neg_lo:[1,0,0]
    v_pk_mul_f32 v[80:81], v[72:73], v[64:65] op_sel:[0,0] op_sel_hi:[1,0]
    v_pk_fma_f32 v[80:81], v[72:73], v[64:65], v[80:81] op_sel:[1,1,0] op_sel_hi:[0,1,1] neg_lo:[1,0,0]
    v_pk_mul_f32 v[88:89], v[72:73], v[72:73] op_sel:[0,0] op_sel_hi:[1,0]
    v_pk_fma_f32 v[88:89], v[72:73], v[72:73], v[88:89] op_sel:[1,1,0] op_sel_hi:[0,1,1] neg_lo:[1,0,0]
    v_mov_b32 v56, 1.0
    v_mov_b32 v57, 0
    v_mov_b32 v18, 0
    v_mov_b32 v19, 0
    v_mov_b32 v2, 159232
L_wait2:
    ds_read_b32 v4, v2 offset:12
    s_waitcnt lgkmcnt(0)
    v_cmp_ne_u32 vcc, 4, v4
    s_cbranch_vccnz L_wait2
    ds_read_b64 v[20:21], v3 offset:0
    ds_read_b64 v[22:23], v3 offset:512
    ds_read_b64 v[24:25], v3 offset:1024
    ds_read_b64 v[26:27], v3 offset:1536
    ds_read_b64 v[28:29], v3 offset:4096
    ds_read_b64 v[30:31], v3 offset:4608
    ds_read_b64 v[32:33], v3 offset:5120
    ds_read_b64 v[34:35], v3 offset:5632
    ds_read_b64 v[36:37], v3 offset:8192
    ds_read_b64 v[38:39], v3 offset:8704
    ds_read_b64 v[40:41], v3 offset:9216
    ds_read_b64 v[42:43], v3 offset:9728
    ds_read_b64 v[44:45], v3 offset:12288
    ds_read_b64 v[46:47], v3 offset:12800
    ds_read_b64 v[48:49], v3 offset:13312
    ds_read_b64 v[50:51], v3 offset:13824
    s_waitcnt lgkmcnt(14)
    v_pk_fma_f32 v[22:23], v[20:21], v[58:59], v[22:23] op_sel:[0,0,0] op_sel_hi:[1,0,1]
    v_pk_fma_f32 v[22:23], v[20:21], v[58:59], v[22:23] op_sel:[1,1,0] op_sel_hi:[0,1,1] neg_lo:[1,0,0]
    s_waitcnt lgkmcnt(13)
    v_pk_fma_f32 v[24:25], v[22:23], v[58:59], v[24:25] op_sel:[0,0,0] op_sel_hi:[1,0,1]
    v_pk_fma_f32 v[24:25], v[22:23], v[58:59], v[24:25] op_sel:[1,1,0] op_sel_hi:[0,1,1] neg_lo:[1,0,0]
    s_waitcnt lgkmcnt(12)
    v_pk_fma_f32 v[26:27], v[24:25], v[58:59], v[26:27] op_sel:[0,0,0] op_sel_hi:[1,0,1]
    v_pk_fma_f32 v[26:27], v[24:25], v[58:59], v[26:27] op_sel:[1,1,0] op_sel_hi:[0,1,1] neg_lo:[1,0,0]
    s_waitcnt lgkmcnt(11)
    v_pk_fma_f32 v[28:29], v[26:27], v[58:59], v[28:29] op_sel:[0,0,0] op_sel_hi:[1,0,1]
    v_pk_fma_f32 v[28:29], v[26:27], v[58:59], v[28:29] op_sel:[1,1,0] op_sel_hi:[0,1,1] neg_lo:[1,0,0]
    s_waitcnt lgkmcnt(10)
    v_pk_fma_f32 v[30:31], v[28:29], v[58:59], v[30:31] op_sel:[0,0,0] op_sel_hi:[1,0,1]
    v_pk_fma_f32 v[30:31], v[28:29], v[58:59], v[30:31] op_sel:[1,1,0] op_sel_hi:[0,1,1] neg_lo:[1,0,0]
    s_waitcnt lgkmcnt(9)
    v_pk_fma_f32 v[32:33], v[30:31], v[58:59], v[32:33] op_sel:[0,0,0] op_sel_hi:[1,0,1]
    v_pk_fma_f32 v[32:33], v[30:31], v[58:59], v[32:33] op_sel:[1,1,0] op_sel_hi:[0,1,1] neg_lo:[1,0,0]
    s_waitcnt lgkmcnt(8)
    v_pk_fma_f32 v[34:35], v[32:33], v[58:59], v[34:35] op_sel:[0,0,0] op_sel_hi:[1,0,1]
    v_pk_fma_f32 v[34:35], v[32:33], v[58:59], v[34:35] op_sel:[1,1,0] op_sel_hi:[0,1,1] neg_lo:[1,0,0]
    s_waitcnt lgkmcnt(7)
    v_pk_fma_f32 v[36:37], v[34:35], v[58:59], v[36:37] op_sel:[0,0,0] op_sel_hi:[1,0,1]
    v_pk_fma_f32 v[36:37], v[34:35], v[58:59], v[36:37] op_sel:[1,1,0] op_sel_hi:[0,1,1] neg_lo:[1,0,0]
    s_waitcnt lgkmcnt(6)
    v_pk_fma_f32 v[38:39], v[36:37], v[58:59], v[38:39] op_sel:[0,0,0] op_sel_hi:[1,0,1]
    v_pk_fma_f32 v[38:39], v[36:37], v[58:59], v[38:39] op_sel:[1,1,0] op_sel_hi:[0,1,1] neg_lo:[1,0,0]
    s_waitcnt lgkmcnt(5)
    v_pk_fma_f32 v[40:41], v[38:39], v[58:59], v[40:41] op_sel:[0,0,0] op_sel_hi:[1,0,1]
    v_pk_fma_f32 v[40:41], v[38:39], v[58:59], v[40:41] op_sel:[1,1,0] op_sel_hi:[0,1,1] neg_lo:[1,0,0]
    s_waitcnt lgkmcnt(4)
    v_pk_fma_f32 v[42:43], v[40:41], v[58:59], v[42:43] op_sel:[0,0,0] op_sel_hi:[1,0,1]
    v_pk_fma_f32 v[42:43], v[40:41], v[58:59], v[42:43] op_sel:[1,1,0] op_sel_hi:[0,1,1] neg_lo:[1,0,0]
    s_waitcnt lgkmcnt(3)
    v_pk_fma_f32 v[44:45], v[42:43], v[58:59], v[44:45] op_sel:[0,0,0] op_sel_hi:[1,0,1]
    v_pk_fma_f32 v[44:45], v[42:43], v[58:59], v[44:45] op_sel:[1,1,0] op_sel_hi:[0,1,1] neg_lo:[1,0,0]
    s_waitcnt lgkmcnt(2)
    v_pk_fma_f32 v[46:47], v[44:45], v[58:59], v[46:47] op_sel:[0,0,0] op_sel_hi:[1,0,1]
    v_pk_fma_f32 v[46:47], v[44:45], v[58:59], v[46:47] op_sel:[1,1,0] op_sel_hi:[0,1,1] neg_lo:[1,0,0]
    s_waitcnt lgkmcnt(1)
    v_pk_fma_f32 v[48:49], v[46:47], v[58:59], v[48:49] op_sel:[0,0,0] op_sel_hi:[1,0,1]
    v_pk_fma_f32 v[48:49], v[46:47], v[58:59], v[48:49] op_sel:[1,1,0] op_sel_hi:[0,1,1] neg_lo:[1,0,0]
    s_waitcnt lgkmcnt(0)
    v_pk_fma_f32 v[50:51], v[48:49], v[58:59], v[50:51] op_sel:[0,0,0] op_sel_hi:[1,0,1]
    v_pk_fma_f32 v[50:51], v[48:49], v[58:59], v[50:51] op_sel:[1,1,0] op_sel_hi:[0,1,1] neg_lo:[1,0,0]
    buffer_store_dwordx4 v[50:53], v1, s[60:63], s8 offen sc1
    s_mov_b32 s12, 200000
    s_mov_b32 s6, s8
    s_cmp_le_u32 s4, 0
    s_cbranch_scc1 L_issued0
    s_sub_u32 s6, s6, 1024
    buffer_load_dwordx4 v[96:99], v1, s[60:63], s6 offen sc1
    s_cmp_le_u32 s4, 1
    s_cbranch_scc1 L_issued0
    s_sub_u32 s6, s6, 1024
    buffer_load_dwordx4 v[100:103], v1, s[60:63], s6 offen sc1
    s_cmp_le_u32 s4, 2
    s_cbranch_scc1 L_issued0
    s_sub_u32 s6, s6, 1024
    buffer_load_dwordx4 v[104:107], v1, s[60:63], s6 offen sc1
    s_cmp_le_u32 s4, 3
    s_cbranch_scc1 L_issued0
    s_sub_u32 s6, s6, 1024
    buffer_load_dwordx4 v[108:111], v1, s[60:63], s6 offen sc1
    s_cmp_le_u32 s4, 4
    s_cbranch_scc1 L_issued0
    s_sub_u32 s6, s6, 1024
    buffer_load_dwordx4 v[112:115], v1, s[60:63], s6 offen sc1
    s_cmp_le_u32 s4, 5
    s_cbranch_scc1 L_issued0
    s_sub_u32 s6, s6, 1024
    buffer_load_dwordx4 v[116:119], v1, s[60:63], s6 offen sc1
    s_cmp_le_u32 s4, 6
    s_cbranch_scc1 L_issued0
    s_sub_u32 s6, s6, 1024
    buffer_load_dwordx4 v[120:123], v1, s[60:63], s6 offen sc1
    s_cmp_le_u32 s4, 7
    s_cbranch_scc1 L_issued0
    s_sub_u32 s6, s6, 1024
    buffer_load_dwordx4 v[124:127], v1, s[60:63], s6 offen sc1
    s_cmp_le_u32 s4, 8
    s_cbranch_scc1 L_issued0
    s_sub_u32 s6, s6, 1024
    buffer_load_dwordx4 v[128:131], v1, s[60:63], s6 offen sc1
    s_cmp_le_u32 s4, 9
    s_cbranch_scc1 L_issued0
    s_sub_u32 s6, s6, 1024
    buffer_load_dwordx4 v[132:135], v1, s[60:63], s6 offen sc1
    s_cmp_le_u32 s4, 10
    s_cbranch_scc1 L_issued0
    s_sub_u32 s6, s6, 1024
    buffer_load_dwordx4 v[136:139], v1, s[60:63], s6 offen sc1
    s_cmp_le_u32 s4, 11
    s_cbranch_scc1 L_issued0
    s_sub_u32 s6, s6, 1024
    buffer_load_dwordx4 v[140:143], v1, s[60:63], s6 offen sc1
    s_cmp_le_u32 s4, 12
    s_cbranch_scc1 L_issued0
    s_sub_u32 s6, s6, 1024
    buffer_load_dwordx4 v[144:147], v1, s[60:63], s6 offen sc1
    s_cmp_le_u32 s4, 13
    s_cbranch_scc1 L_issued0
    s_sub_u32 s6, s6, 1024
    buffer_load_dwordx4 v[148:151], v1, s[60:63], s6 offen sc1
    s_cmp_le_u32 s4, 14
    s_cbranch_scc1 L_issued0
    s_sub_u32 s6, s6, 1024
    buffer_load_dwordx4 v[152:155], v1, s[60:63], s6 offen sc1
L_issued0:
    ds_write_b64 v3, v[18:19] offset:0
    ds_write_b64 v3, v[20:21] offset:512
    ds_write_b64 v3, v[22:23] offset:1024
    ds_write_b64 v3, v[24:25] offset:1536
    ds_write_b64 v3, v[26:27] offset:4096
    ds_write_b64 v3, v[28:29] offset:4608
    ds_write_b64 v3, v[30:31] offset:5120
    ds_write_b64 v3, v[32:33] offset:5632
    ds_write_b64 v3, v[34:35] offset:8192
    ds_write_b64 v3, v[36:37] offset:8704
    ds_write_b64 v3, v[38:39] offset:9216
    ds_write_b64 v3, v[40:41] offset:9728
    ds_write_b64 v3, v[42:43] offset:12288
    ds_write_b64 v3, v[44:45] offset:12800
    ds_write_b64 v3, v[46:47] offset:13312
    ds_write_b64 v3, v[48:49] offset:13824
    ds_write_b64 v3, v[56:57] offset:2048
    ds_write_b64 v3, v[56:57] offset:10240
    ds_write_b64 v3, v[58:59] offset:2560
    ds_write_b64 v3, v[64:65] offset:10752
    ds_write_b64 v3, v[60:61] offset:6144
    ds_write_b64 v3, v[72:73] offset:14336
    ds_write_b64 v3, v[62:63] offset:6656
    ds_write_b64 v3, v[80:81] offset:14848
    ds_write_b32 v2, v52 offset:8
    s_branch L_check
L_poll:
    v_cmp_ne_u32 vcc, v98, v52
    s_sub_u32 s6, s8, 1024
    s_cbranch_vccz L_pk0
    buffer_load_dwordx4 v[96:99], v1, s[60:63], s6 offen sc1
L_pk0:
    v_cmp_ne_u32 vcc, v102, v52
    s_sub_u32 s6, s8, 2048
    s_cbranch_vccz L_pk1
    buffer_load_dwordx4 v[100:103], v1, s[60:63], s6 offen sc1
L_pk1:
    v_cmp_ne_u32 vcc, v106, v52
    s_sub_u32 s6, s8, 3072
    s_cbranch_vccz L_pk2
    buffer_load_dwordx4 v[104:107], v1, s[60:63], s6 offen sc1
L_pk2:
    v_cmp_ne_u32 vcc, v110, v52
    s_sub_u32 s6, s8, 4096
    s_cbranch_vccz L_pk3
    buffer_load_dwordx4 v[108:111], v1, s[60:63], s6 offen sc1
L_pk3:
    v_cmp_ne_u32 vcc, v114, v52
    s_sub_u32 s6, s8, 5120
    s_cbranch_vccz L_pk4
    buffer_load_dwordx4 v[112:115], v1, s[60:63], s6 offen sc1
L_pk4:
    v_cmp_ne_u32 vcc, v118, v52
    s_sub_u32 s6, s8, 6144
    s_cbranch_vccz L_pk5
    buffer_load_dwordx4 v[116:119], v1, s[60:63], s6 offen sc1
L_pk5:
    v_cmp_ne_u32 vcc, v122, v52
    s_sub_u32 s6, s8, 7168
    s_cbranch_vccz L_pk6
    buffer_load_dwordx4 v[120:123], v1, s[60:63], s6 offen sc1
L_pk6:
    v_cmp_ne_u32 vcc, v126, v52
    s_sub_u32 s6, s8, 8192
    s_cbranch_vccz L_pk7
    buffer_load_dwordx4 v[124:127], v1, s[60:63], s6 offen sc1
L_pk7:
    v_cmp_ne_u32 vcc, v130, v52
    s_sub_u32 s6, s8, 9216
    s_cbranch_vccz L_pk8
    buffer_load_dwordx4 v[128:131], v1, s[60:63], s6 offen sc1
L_pk8:
    v_cmp_ne_u32 vcc, v134, v52
    s_sub_u32 s6, s8, 10240
    s_cbranch_vccz L_pk9
    buffer_load_dwordx4 v[132:135], v1, s[60:63], s6 offen sc1
L_pk9:
    v_cmp_ne_u32 vcc, v138, v52
    s_sub_u32 s6, s8, 11264
    s_cbranch_vccz L_pk10
    buffer_load_dwordx4 v[136:139], v1, s[60:63], s6 offen sc1
L_pk10:
    v_cmp_ne_u32 vcc, v142, v52
    s_sub_u32 s6, s8, 12288
    s_cbranch_vccz L_pk11
    buffer_load_dwordx4 v[140:143], v1, s[60:63], s6 offen sc1
L_pk11:
    v_cmp_ne_u32 vcc, v146, v52
    s_sub_u32 s6, s8, 13312
    s_cbranch_vccz L_pk12
    buffer_load_dwordx4 v[144:147], v1, s[60:63], s6 offen sc1
L_pk12:
    v_cmp_ne_u32 vcc, v150, v52
    s_sub_u32 s6, s8, 14336
    s_cbranch_vccz L_pk13
    buffer_load_dwordx4 v[148:151], v1, s[60:63], s6 offen sc1
L_pk13:
    v_cmp_ne_u32 vcc, v154, v52
    s_sub_u32 s6, s8, 15360
    s_cbranch_vccz L_pk14
    buffer_load_dwordx4 v[152:155], v1, s[60:63], s6 offen sc1
L_pk14:
L_check:
    s_waitcnt vmcnt(0)
    v_xor_b32 v4, v52, v98
    v_bitop3_b32 v4, v4, v102, v52 bitop3:0xf6
    v_bitop3_b32 v4, v4, v106, v52 bitop3:0xf6
    v_bitop3_b32 v4, v4, v110, v52 bitop3:0xf6
    v_bitop3_b32 v4, v4, v114, v52 bitop3:0xf6
    v_bitop3_b32 v4, v4, v118, v52 bitop3:0xf6
    v_bitop3_b32 v4, v4, v122, v52 bitop3:0xf6
    v_bitop3_b32 v4, v4, v126, v52 bitop3:0xf6
    v_bitop3_b32 v4, v4, v130, v52 bitop3:0xf6
    v_bitop3_b32 v4, v4, v134, v52 bitop3:0xf6
    v_bitop3_b32 v4, v4, v138, v52 bitop3:0xf6
    v_bitop3_b32 v4, v4, v142, v52 bitop3:0xf6
    v_bitop3_b32 v4, v4, v146, v52 bitop3:0xf6
    v_bitop3_b32 v4, v4, v150, v52 bitop3:0xf6
    v_bitop3_b32 v4, v4, v154, v52 bitop3:0xf6
    v_cmp_ne_u32 vcc, 0, v4
    s_sub_u32 s12, s12, 1
    s_cbranch_scc1 L_polled
    s_cbranch_vccnz L_poll
L_polled:
    v_pk_fma_f32 v[148:149], v[152:153], v[88:89], v[148:149] op_sel:[0,0,0] op_sel_hi:[1,0,1]
    v_pk_fma_f32 v[148:149], v[152:153], v[88:89], v[148:149] op_sel:[1,1,0] op_sel_hi:[0,1,1] neg_lo:[1,0,0]
    v_pk_fma_f32 v[144:145], v[148:149], v[88:89], v[144:145] op_sel:[0,0,0] op_sel_hi:[1,0,1]
    v_pk_fma_f32 v[144:145], v[148:149], v[88:89], v[144:145] op_sel:[1,1,0] op_sel_hi:[0,1,1] neg_lo:[1,0,0]
    v_pk_fma_f32 v[140:141], v[144:145], v[88:89], v[140:141] op_sel:[0,0,0] op_sel_hi:[1,0,1]
    v_pk_fma_f32 v[140:141], v[144:145], v[88:89], v[140:141] op_sel:[1,1,0] op_sel_hi:[0,1,1] neg_lo:[1,0,0]
    v_pk_fma_f32 v[136:137], v[140:141], v[88:89], v[136:137] op_sel:[0,0,0] op_sel_hi:[1,0,1]
    v_pk_fma_f32 v[136:137], v[140:141], v[88:89], v[136:137] op_sel:[1,1,0] op_sel_hi:[0,1,1] neg_lo:[1,0,0]
    v_pk_fma_f32 v[132:133], v[136:137], v[88:89], v[132:133] op_sel:[0,0,0] op_sel_hi:[1,0,1]
    v_pk_fma_f32 v[132:133], v[136:137], v[88:89], v[132:133] op_sel:[1,1,0] op_sel_hi:[0,1,1] neg_lo:[1,0,0]
    v_pk_fma_f32 v[128:129], v[132:133], v[88:89], v[128:129] op_sel:[0,0,0] op_sel_hi:[1,0,1]
    v_pk_fma_f32 v[128:129], v[132:133], v[88:89], v[128:129] op_sel:[1,1,0] op_sel_hi:[0,1,1] neg_lo:[1,0,0]
    v_pk_fma_f32 v[124:125], v[128:129], v[88:89], v[124:125] op_sel:[0,0,0] op_sel_hi:[1,0,1]
    v_pk_fma_f32 v[124:125], v[128:129], v[88:89], v[124:125] op_sel:[1,1,0] op_sel_hi:[0,1,1] neg_lo:[1,0,0]
    v_pk_fma_f32 v[120:121], v[124:125], v[88:89], v[120:121] op_sel:[0,0,0] op_sel_hi:[1,0,1]
    v_pk_fma_f32 v[120:121], v[124:125], v[88:89], v[120:121] op_sel:[1,1,0] op_sel_hi:[0,1,1] neg_lo:[1,0,0]
    v_pk_fma_f32 v[116:117], v[120:121], v[88:89], v[116:117] op_sel:[0,0,0] op_sel_hi:[1,0,1]
    v_pk_fma_f32 v[116:117], v[120:121], v[88:89], v[116:117] op_sel:[1,1,0] op_sel_hi:[0,1,1] neg_lo:[1,0,0]
    v_pk_fma_f32 v[112:113], v[116:117], v[88:89], v[112:113] op_sel:[0,0,0] op_sel_hi:[1,0,1]
    v_pk_fma_f32 v[112:113], v[116:117], v[88:89], v[112:113] op_sel:[1,1,0] op_sel_hi:[0,1,1] neg_lo:[1,0,0]
    v_pk_fma_f32 v[108:109], v[112:113], v[88:89], v[108:109] op_sel:[0,0,0] op_sel_hi:[1,0,1]
    v_pk_fma_f32 v[108:109], v[112:113], v[88:89], v[108:109] op_sel:[1,1,0] op_sel_hi:[0,1,1] neg_lo:[1,0,0]
    v_pk_fma_f32 v[104:105], v[108:109], v[88:89], v[104:105] op_sel:[0,0,0] op_sel_hi:[1,0,1]
    v_pk_fma_f32 v[104:105], v[108:109], v[88:89], v[104:105] op_sel:[1,1,0] op_sel_hi:[0,1,1] neg_lo:[1,0,0]
    v_pk_fma_f32 v[100:101], v[104:105], v[88:89], v[100:101] op_sel:[0,0,0] op_sel_hi:[1,0,1]
    v_pk_fma_f32 v[100:101], v[104:105], v[88:89], v[100:101] op_sel:[1,1,0] op_sel_hi:[0,1,1] neg_lo:[1,0,0]
    v_pk_fma_f32 v[96:97], v[100:101], v[88:89], v[96:97] op_sel:[0,0,0] op_sel_hi:[1,0,1]
    v_pk_fma_f32 v[96:97], v[100:101], v[88:89], v[96:97] op_sel:[1,1,0] op_sel_hi:[0,1,1] neg_lo:[1,0,0]
    ds_write_b64 v3, v[96:97] offset:15360
    ds_write_b32 v2, v52
    v_mov_b32 v100, v52
    v_mov_b32 v101, v8
    v_and_b32 v4, 15, v0
    v_lshrrev_b32 v5, 4, v0
    v_lshrrev_b32 v6, 1, v4
    v_xor_b32 v6, v6, v5
    v_lshlrev_b32 v6, 4, v6
    v_lshl_add_u32 v248, v4, 7, v6
    s_sub_u32 s11, s3, 4
    s_lshl_b32 s8, s4, 7
    s_lshl_b32 s9, s11, 5
    s_add_u32 s10, s8, s9
    v_lshl_add_u32 v6, v5, 3, s10
    v_add_u32 v6, 4, v6
    v_mul_u32_u24 v3, 4608, v6
    v_lshl_add_u32 v3, v4, 4, v3
    s_lshl_b32 s8, s4, 2
    s_add_u32 s8, s8, s11
    s_mul_i32 s12, s8, 73856
    s_add_u32 s13, s12, 36864
    s_lshl_b32 s8, s5, 12
    s_add_u32 s14, s12, s8
    s_add_u32 s15, s13, s8
    v_lshlrev_b32 v1, 4, v0
    v_add_u32 v1, 36864, v1
    v_mov_b32 v216, 0
    v_mov_b32 v217, 0
    v_mov_b32 v218, 0
    v_mov_b32 v219, 0
    v_mov_b32 v220, 0
    v_mov_b32 v221, 0
    v_mov_b32 v222, 0
    v_mov_b32 v223, 0
    v_mov_b32 v224, 0
    v_mov_b32 v225, 0
    v_mov_b32 v226, 0
    v_mov_b32 v227, 0
    v_mov_b32 v228, 0
    v_mov_b32 v229, 0
    v_mov_b32 v230, 0
    v_mov_b32 v231, 0
    s_mov_b32 s60, s52
    s_mov_b32 s61, s53
    s_mov_b32 s62, 0x10000000
    s_mov_b32 s63, 0x20000
    s_mov_b32 s64, s48
    s_mov_b32 s65, s49
    s_mov_b32 s66, 0x900000
    s_mov_b32 s67, 0x20000
    s_mov_b64 exec, 0x1ff
    s_mov_b32 s6, 200000
L_poll2:
    buffer_load_dword v102, v101, s[60:63], s79 offen sc1
    s_waitcnt vmcnt(0)
    v_cmp_ne_u32 vcc, v102, v100
    s_sub_u32 s6, s6, 1
    s_cbranch_scc1 L_polled2
    s_cbranch_vccnz L_poll2
L_polled2:
    s_mov_b64 exec, -1
    s_setprio 0
    s_branch L_B_g2
L_B_comp:
    v_and_b32 v4, 15, v0
    v_lshrrev_b32 v5, 4, v0
    v_lshrrev_b32 v6, 1, v4
    v_xor_b32 v6, v6, v5
    v_lshlrev_b32 v6, 4, v6
    v_lshl_add_u32 v248, v4, 7, v6
    s_lshl_b32 s8, s4, 7
    s_lshl_b32 s9, s3, 5
    s_add_u32 s10, s8, s9
    v_xor_b32 v249, 64, v248
    s_lshl_b32 s79, s3, 12
    v_add_u32 v250, s79, v248
    v_add_u32 v251, s79, v249
    v_add_u32 v252, 0x10000, v248
    v_add_u32 v253, 0x10000, v249
    v_add_u32 v254, 0x10000, v250
    v_add_u32 v255, 0x10000, v251
    v_lshlrev_b32 v6, 4, v4
    v_add_u32 v6, 149504, v6
    v_lshlrev_b32 v7, 3, v4
    v_add_u32 v7, 154624, v7
    s_add_u32 s79, s79, 147456
    v_lshlrev_b32 v2, 9, v5
    v_lshl_add_u32 v2, v4, 5, v2
    v_add_u32 v2, s79, v2
    v_mov_b32 v208, 0
    s_lshl_b32 s9, s5, 2
    v_lshlrev_b32 v1, 4, v0
    v_add_u32 v210, 149504, v1
    v_cmp_lt_u32 vcc, 31, v0
    v_mov_b32 v211, 154624
    v_mov_b32 v3, 162304
    v_cndmask_b32 v211, v211, v3, vcc
    v_add_u32 v211, v211, v1
    v_mov_b32 v3, 159232
    v_mov_b32 v216, 0
    v_mov_b32 v217, 0
    v_mov_b32 v218, 0
    v_mov_b32 v219, 0
    ds_write_b128 v3, v[216:219]
    ds_write_b128 v3, v[216:219] offset:16
    ds_write_b128 v3, v[216:219] offset:32
    s_waitcnt lgkmcnt(0)
    s_mov_b32 s60, s52
    s_mov_b32 s61, s53
    s_mov_b32 s62, 0x10000000
    s_mov_b32 s63, 0x20000
    s_mov_b32 s56, s30
    s_mov_b32 s57, s31
    s_mov_b32 s58, 0x240000
    s_mov_b32 s59, 0x20000
    s_mov_b32 s64, s48
    s_mov_b32 s65, s49
    s_mov_b32 s66, 0x900000
    s_mov_b32 s67, 0x20000
    s_mov_b32 s68, s46
    s_mov_b32 s69, s47
    s_mov_b32 s70, 0x480
    s_mov_b32 s71, 0x20000
    s_mov_b32 s72, s50
    s_mov_b32 s73, s51
    s_mov_b32 s74, 0x100
    s_mov_b32 s75, 0x20000
    s_barrier
    ds_read_b128 v[192:195], v250 offset:0
    ds_read_b128 v[196:199], v250 offset:2048
    ds_read_b128 v[72:75], v248 offset:16384
    ds_read_b128 v[76:79], v248 offset:18432
    ds_read_b128 v[80:83], v248 offset:20480
    ds_read_b128 v[84:87], v248 offset:22528
    ds_read_b128 v[88:91], v248 offset:24576
    ds_read_b128 v[92:95], v248 offset:26624
    ds_read_b128 v[96:99], v248 offset:28672
    ds_read_b128 v[100:103], v248 offset:30720
    ds_read_b128 v[200:203], v251 offset:0
    ds_read_b128 v[204:207], v251 offset:2048
    s_waitcnt lgkmcnt(9)
    v_mfma_f32_16x16x32_bf16 v[8:11], v[192:195], v[72:75], 0
    v_mfma_f32_16x16x32_bf16 v[40:43], v[196:199], v[72:75], 0
    ds_read_b128 v[72:75], v249 offset:16384
    s_waitcnt lgkmcnt(9)
    v_mfma_f32_16x16x32_bf16 v[12:15], v[192:195], v[76:79], 0
    v_mfma_f32_16x16x32_bf16 v[44:47], v[196:199], v[76:79], 0
    ds_read_b128 v[76:79], v249 offset:18432
    s_waitcnt lgkmcnt(9)
    v_mfma_f32_16x16x32_bf16 v[16:19], v[192:195], v[80:83], 0
    v_mfma_f32_16x16x32_bf16 v[48:51], v[196:199], v[80:83], 0
    ds_read_b128 v[80:83], v249 offset:20480
    s_waitcnt lgkmcnt(9)
    v_mfma_f32_16x16x32_bf16 v[20:23], v[192:195], v[84:87], 0
    v_mfma_f32_16x16x32_bf16 v[52:55], v[196:199], v[84:87], 0
    ds_read_b128 v[84:87], v249 offset:22528
    s_waitcnt lgkmcnt(9)
    v_mfma_f32_16x16x32_bf16 v[24:27], v[192:195], v[88:91], 0
    v_mfma_f32_16x16x32_bf16 v[56:59], v[196:199], v[88:91], 0
    ds_read_b128 v[88:91], v249 offset:24576
    s_waitcnt lgkmcnt(9)
    v_mfma_f32_16x16x32_bf16 v[28:31], v[192:195], v[92:95], 0
    v_mfma_f32_16x16x32_bf16 v[60:63], v[196:199], v[92:95], 0
    ds_read_b128 v[92:95], v249 offset:26624
    s_waitcnt lgkmcnt(9)
    v_mfma_f32_16x16x32_bf16 v[32:35], v[192:195], v[96:99], 0
    v_mfma_f32_16x16x32_bf16 v[64:67], v[196:199], v[96:99], 0
    ds_read_b128 v[96:99], v249 offset:28672
    s_waitcnt lgkmcnt(9)
    v_mfma_f32_16x16x32_bf16 v[36:39], v[192:195], v[100:103], 0
    v_mfma_f32_16x16x32_bf16 v[68:71], v[196:199], v[100:103], 0
    ds_read_b128 v[100:103], v249 offset:30720
    s_waitcnt lgkmcnt(7)
    v_mfma_f32_16x16x32_bf16 v[8:11], v[200:203], v[72:75], v[8:11]
    v_mfma_f32_16x16x32_bf16 v[40:43], v[204:207], v[72:75], v[40:43]
    s_waitcnt lgkmcnt(6)
    v_mfma_f32_16x16x32_bf16 v[12:15], v[200:203], v[76:79], v[12:15]
    v_mfma_f32_16x16x32_bf16 v[44:47], v[204:207], v[76:79], v[44:47]
    s_waitcnt lgkmcnt(0)
    s_barrier
    ds_read_b128 v[192:195], v250 offset:32768
    ds_read_b128 v[196:199], v250 offset:34816
    ds_read_b128 v[72:75], v248 offset:49152
    ds_read_b128 v[76:79], v248 offset:51200
    v_mfma_f32_16x16x32_bf16 v[16:19], v[200:203], v[80:83], v[16:19]
    v_mfma_f32_16x16x32_bf16 v[48:51], v[204:207], v[80:83], v[48:51]
    ds_read_b128 v[80:83], v248 offset:53248
    v_mfma_f32_16x16x32_bf16 v[20:23], v[200:203], v[84:87], v[20:23]
    v_mfma_f32_16x16x32_bf16 v[52:55], v[204:207], v[84:87], v[52:55]
    ds_read_b128 v[84:87], v248 offset:55296
    v_mfma_f32_16x16x32_bf16 v[24:27], v[200:203], v[88:91], v[24:27]
    v_mfma_f32_16x16x32_bf16 v[56:59], v[204:207], v[88:91], v[56:59]
    ds_read_b128 v[88:91], v248 offset:57344
    v_mfma_f32_16x16x32_bf16 v[28:31], v[200:203], v[92:95], v[28:31]
    v_mfma_f32_16x16x32_bf16 v[60:63], v[204:207], v[92:95], v[60:63]
    ds_read_b128 v[92:95], v248 offset:59392
    v_mfma_f32_16x16x32_bf16 v[32:35], v[200:203], v[96:99], v[32:35]
    v_mfma_f32_16x16x32_bf16 v[64:67], v[204:207], v[96:99], v[64:67]
    ds_read_b128 v[96:99], v248 offset:61440
    v_mfma_f32_16x16x32_bf16 v[36:39], v[200:203], v[100:103], v[36:39]
    v_mfma_f32_16x16x32_bf16 v[68:71], v[204:207], v[100:103], v[68:71]
    ds_read_b128 v[100:103], v248 offset:63488
    ds_read_b128 v[200:203], v251 offset:32768
    ds_read_b128 v[204:207], v251 offset:34816
    s_waitcnt lgkmcnt(9)
    v_mfma_f32_16x16x32_bf16 v[8:11], v[192:195], v[72:75], v[8:11]
    v_mfma_f32_16x16x32_bf16 v[40:43], v[196:199], v[72:75], v[40:43]
    ds_read_b128 v[72:75], v249 offset:49152
    s_waitcnt lgkmcnt(9)
    v_mfma_f32_16x16x32_bf16 v[12:15], v[192:195], v[76:79], v[12:15]
    v_mfma_f32_16x16x32_bf16 v[44:47], v[196:199], v[76:79], v[44:47]
    ds_read_b128 v[76:79], v249 offset:51200
    s_waitcnt lgkmcnt(9)
    v_mfma_f32_16x16x32_bf16 v[16:19], v[192:195], v[80:83], v[16:19]
    v_mfma_f32_16x16x32_bf16 v[48:51], v[196:199], v[80:83], v[48:51]
    ds_read_b128 v[80:83], v249 offset:53248
    s_waitcnt lgkmcnt(9)
    v_mfma_f32_16x16x32_bf16 v[20:23], v[192:195], v[84:87], v[20:23]
    v_mfma_f32_16x16x32_bf16 v[52:55], v[196:199], v[84:87], v[52:55]
    ds_read_b128 v[84:87], v249 offset:55296
    s_waitcnt lgkmcnt(9)
    v_mfma_f32_16x16x32_bf16 v[24:27], v[192:195], v[88:91], v[24:27]
    v_mfma_f32_16x16x32_bf16 v[56:59], v[196:199], v[88:91], v[56:59]
    ds_read_b128 v[88:91], v249 offset:57344
    s_waitcnt lgkmcnt(9)
    v_mfma_f32_16x16x32_bf16 v[28:31], v[192:195], v[92:95], v[28:31]
    v_mfma_f32_16x16x32_bf16 v[60:63], v[196:199], v[92:95], v[60:63]
    ds_read_b128 v[92:95], v249 offset:59392
    s_waitcnt lgkmcnt(9)
    v_mfma_f32_16x16x32_bf16 v[32:35], v[192:195], v[96:99], v[32:35]
    v_mfma_f32_16x16x32_bf16 v[64:67], v[196:199], v[96:99], v[64:67]
    ds_read_b128 v[96:99], v249 offset:61440
    s_waitcnt lgkmcnt(9)
    v_mfma_f32_16x16x32_bf16 v[36:39], v[192:195], v[100:103], v[36:39]
    v_mfma_f32_16x16x32_bf16 v[68:71], v[196:199], v[100:103], v[68:71]
    ds_read_b128 v[100:103], v249 offset:63488
    s_waitcnt lgkmcnt(7)
    v_mfma_f32_16x16x32_bf16 v[8:11], v[200:203], v[72:75], v[8:11]
    v_mfma_f32_16x16x32_bf16 v[40:43], v[204:207], v[72:75], v[40:43]
    s_waitcnt lgkmcnt(6)
    v_mfma_f32_16x16x32_bf16 v[12:15], v[200:203], v[76:79], v[12:15]
    v_mfma_f32_16x16x32_bf16 v[44:47], v[204:207], v[76:79], v[44:47]
    s_waitcnt lgkmcnt(0)
    s_barrier
    ds_read_b128 v[192:195], v254 offset:0
    ds_read_b128 v[196:199], v254 offset:2048
    ds_read_b128 v[72:75], v252 offset:16384
    ds_read_b128 v[76:79], v252 offset:18432
    v_mfma_f32_16x16x32_bf16 v[16:19], v[200:203], v[80:83], v[16:19]
    v_mfma_f32_16x16x32_bf16 v[48:51], v[204:207], v[80:83], v[48:51]
    ds_read_b128 v[80:83], v252 offset:20480
    v_mfma_f32_16x16x32_bf16 v[20:23], v[200:203], v[84:87], v[20:23]
    v_mfma_f32_16x16x32_bf16 v[52:55], v[204:207], v[84:87], v[52:55]
    ds_read_b128 v[84:87], v252 offset:22528
    v_mfma_f32_16x16x32_bf16 v[24:27], v[200:203], v[88:91], v[24:27]
    v_mfma_f32_16x16x32_bf16 v[56:59], v[204:207], v[88:91], v[56:59]
    ds_read_b128 v[88:91], v252 offset:24576
    v_mfma_f32_16x16x32_bf16 v[28:31], v[200:203], v[92:95], v[28:31]
    v_mfma_f32_16x16x32_bf16 v[60:63], v[204:207], v[92:95], v[60:63]
    ds_read_b128 v[92:95], v252 offset:26624
    v_mfma_f32_16x16x32_bf16 v[32:35], v[200:203], v[96:99], v[32:35]
    v_mfma_f32_16x16x32_bf16 v[64:67], v[204:207], v[96:99], v[64:67]
    ds_read_b128 v[96:99], v252 offset:28672
    v_mfma_f32_16x16x32_bf16 v[36:39], v[200:203], v[100:103], v[36:39]
    v_mfma_f32_16x16x32_bf16 v[68:71], v[204:207], v[100:103], v[68:71]
    ds_read_b128 v[100:103], v252 offset:30720
    ds_read_b128 v[200:203], v255 offset:0
    ds_read_b128 v[204:207], v255 offset:2048
    s_waitcnt lgkmcnt(9)
    v_mfma_f32_16x16x32_bf16 v[8:11], v[192:195], v[72:75], v[8:11]
    v_mfma_f32_16x16x32_bf16 v[40:43], v[196:199], v[72:75], v[40:43]
    ds_read_b128 v[72:75], v253 offset:16384
    s_waitcnt lgkmcnt(9)
    v_mfma_f32_16x16x32_bf16 v[12:15], v[192:195], v[76:79], v[12:15]
    v_mfma_f32_16x16x32_bf16 v[44:47], v[196:199], v[76:79], v[44:47]
    ds_read_b128 v[76:79], v253 offset:18432
    s_waitcnt lgkmcnt(9)
    v_mfma_f32_16x16x32_bf16 v[16:19], v[192:195], v[80:83], v[16:19]
    v_mfma_f32_16x16x32_bf16 v[48:51], v[196:199], v[80:83], v[48:51]
    ds_read_b128 v[80:83], v253 offset:20480
    s_waitcnt lgkmcnt(9)
    v_mfma_f32_16x16x32_bf16 v[20:23], v[192:195], v[84:87], v[20:23]
    v_mfma_f32_16x16x32_bf16 v[52:55], v[196:199], v[84:87], v[52:55]
    ds_read_b128 v[84:87], v253 offset:22528
    s_waitcnt lgkmcnt(9)
    v_mfma_f32_16x16x32_bf16 v[24:27], v[192:195], v[88:91], v[24:27]
    v_mfma_f32_16x16x32_bf16 v[56:59], v[196:199], v[88:91], v[56:59]
    ds_read_b128 v[88:91], v253 offset:24576
    s_waitcnt lgkmcnt(9)
    v_mfma_f32_16x16x32_bf16 v[28:31], v[192:195], v[92:95], v[28:31]
    v_mfma_f32_16x16x32_bf16 v[60:63], v[196:199], v[92:95], v[60:63]
    ds_read_b128 v[92:95], v253 offset:26624
    s_waitcnt lgkmcnt(9)
    v_mfma_f32_16x16x32_bf16 v[32:35], v[192:195], v[96:99], v[32:35]
    v_mfma_f32_16x16x32_bf16 v[64:67], v[196:199], v[96:99], v[64:67]
    ds_read_b128 v[96:99], v253 offset:28672
    s_waitcnt lgkmcnt(9)
    v_mfma_f32_16x16x32_bf16 v[36:39], v[192:195], v[100:103], v[36:39]
    v_mfma_f32_16x16x32_bf16 v[68:71], v[196:199], v[100:103], v[68:71]
    ds_read_b128 v[100:103], v253 offset:30720
    s_waitcnt lgkmcnt(7)
    v_mfma_f32_16x16x32_bf16 v[8:11], v[200:203], v[72:75], v[8:11]
    v_mfma_f32_16x16x32_bf16 v[40:43], v[204:207], v[72:75], v[40:43]
    s_waitcnt lgkmcnt(6)
    v_mfma_f32_16x16x32_bf16 v[12:15], v[200:203], v[76:79], v[12:15]
    v_mfma_f32_16x16x32_bf16 v[44:47], v[204:207], v[76:79], v[44:47]
    s_waitcnt lgkmcnt(0)
    s_barrier
    ds_read_b128 v[192:195], v254 offset:32768
    ds_read_b128 v[196:199], v254 offset:34816
    ds_read_b128 v[72:75], v252 offset:49152
    ds_read_b128 v[76:79], v252 offset:51200
    v_mfma_f32_16x16x32_bf16 v[16:19], v[200:203], v[80:83], v[16:19]
    v_mfma_f32_16x16x32_bf16 v[48:51], v[204:207], v[80:83], v[48:51]
    ds_read_b128 v[80:83], v252 offset:53248
    v_mfma_f32_16x16x32_bf16 v[20:23], v[200:203], v[84:87], v[20:23]
    v_mfma_f32_16x16x32_bf16 v[52:55], v[204:207], v[84:87], v[52:55]
    ds_read_b128 v[84:87], v252 offset:55296
    v_mfma_f32_16x16x32_bf16 v[24:27], v[200:203], v[88:91], v[24:27]
    v_mfma_f32_16x16x32_bf16 v[56:59], v[204:207], v[88:91], v[56:59]
    ds_read_b128 v[88:91], v252 offset:57344
    v_mfma_f32_16x16x32_bf16 v[28:31], v[200:203], v[92:95], v[28:31]
    v_mfma_f32_16x16x32_bf16 v[60:63], v[204:207], v[92:95], v[60:63]
    ds_read_b128 v[92:95], v252 offset:59392
    v_mfma_f32_16x16x32_bf16 v[32:35], v[200:203], v[96:99], v[32:35]
    v_mfma_f32_16x16x32_bf16 v[64:67], v[204:207], v[96:99], v[64:67]
    ds_read_b128 v[96:99], v252 offset:61440
    v_mfma_f32_16x16x32_bf16 v[36:39], v[200:203], v[100:103], v[36:39]
    v_mfma_f32_16x16x32_bf16 v[68:71], v[204:207], v[100:103], v[68:71]
    ds_read_b128 v[100:103], v252 offset:63488
    ds_read_b128 v[200:203], v255 offset:32768
    ds_read_b128 v[204:207], v255 offset:34816
    s_waitcnt lgkmcnt(9)
    v_mfma_f32_16x16x32_bf16 v[8:11], v[192:195], v[72:75], v[8:11]
    v_mfma_f32_16x16x32_bf16 v[40:43], v[196:199], v[72:75], v[40:43]
    ds_read_b128 v[72:75], v253 offset:49152
    s_waitcnt lgkmcnt(9)
    v_mfma_f32_16x16x32_bf16 v[12:15], v[192:195], v[76:79], v[12:15]
    v_mfma_f32_16x16x32_bf16 v[44:47], v[196:199], v[76:79], v[44:47]
    ds_read_b128 v[76:79], v253 offset:51200
    s_waitcnt lgkmcnt(9)
    v_mfma_f32_16x16x32_bf16 v[16:19], v[192:195], v[80:83], v[16:19]
    v_mfma_f32_16x16x32_bf16 v[48:51], v[196:199], v[80:83], v[48:51]
    ds_read_b128 v[80:83], v253 offset:53248
    s_waitcnt lgkmcnt(9)
    v_mfma_f32_16x16x32_bf16 v[20:23], v[192:195], v[84:87], v[20:23]
    v_mfma_f32_16x16x32_bf16 v[52:55], v[196:199], v[84:87], v[52:55]
    ds_read_b128 v[84:87], v253 offset:55296
    s_waitcnt lgkmcnt(9)
    v_mfma_f32_16x16x32_bf16 v[24:27], v[192:195], v[88:91], v[24:27]
    v_mfma_f32_16x16x32_bf16 v[56:59], v[196:199], v[88:91], v[56:59]
    ds_read_b128 v[88:91], v253 offset:57344
    s_waitcnt lgkmcnt(9)
    v_mfma_f32_16x16x32_bf16 v[28:31], v[192:195], v[92:95], v[28:31]
    v_mfma_f32_16x16x32_bf16 v[60:63], v[196:199], v[92:95], v[60:63]
    ds_read_b128 v[92:95], v253 offset:59392
    s_waitcnt lgkmcnt(9)
    v_mfma_f32_16x16x32_bf16 v[32:35], v[192:195], v[96:99], v[32:35]
    v_mfma_f32_16x16x32_bf16 v[64:67], v[196:199], v[96:99], v[64:67]
    ds_read_b128 v[96:99], v253 offset:61440
    s_waitcnt lgkmcnt(9)
    v_mfma_f32_16x16x32_bf16 v[36:39], v[192:195], v[100:103], v[36:39]
    v_mfma_f32_16x16x32_bf16 v[68:71], v[196:199], v[100:103], v[68:71]
    ds_read_b128 v[100:103], v253 offset:63488
    s_waitcnt lgkmcnt(7)
    v_mfma_f32_16x16x32_bf16 v[8:11], v[200:203], v[72:75], v[8:11]
    v_mfma_f32_16x16x32_bf16 v[40:43], v[204:207], v[72:75], v[40:43]
    s_waitcnt lgkmcnt(6)
    v_mfma_f32_16x16x32_bf16 v[12:15], v[200:203], v[76:79], v[12:15]
    v_mfma_f32_16x16x32_bf16 v[44:47], v[204:207], v[76:79], v[44:47]
    s_waitcnt lgkmcnt(0)
    s_barrier
    ds_read_b128 v[192:195], v250 offset:0
    ds_read_b128 v[196:199], v250 offset:2048
    ds_read_b128 v[72:75], v248 offset:16384
    ds_read_b128 v[76:79], v248 offset:18432
    v_mfma_f32_16x16x32_bf16 v[16:19], v[200:203], v[80:83], v[16:19]
    v_mfma_f32_16x16x32_bf16 v[48:51], v[204:207], v[80:83], v[48:51]
    ds_read_b128 v[80:83], v248 offset:20480
    v_mfma_f32_16x16x32_bf16 v[20:23], v[200:203], v[84:87], v[20:23]
    v_mfma_f32_16x16x32_bf16 v[52:55], v[204:207], v[84:87], v[52:55]
    ds_read_b128 v[84:87], v248 offset:22528
    v_mfma_f32_16x16x32_bf16 v[24:27], v[200:203], v[88:91], v[24:27]
    v_mfma_f32_16x16x32_bf16 v[56:59], v[204:207], v[88:91], v[56:59]
    ds_read_b128 v[88:91], v248 offset:24576
    v_mfma_f32_16x16x32_bf16 v[28:31], v[200:203], v[92:95], v[28:31]
    v_mfma_f32_16x16x32_bf16 v[60:63], v[204:207], v[92:95], v[60:63]
    ds_read_b128 v[92:95], v248 offset:26624
    v_mfma_f32_16x16x32_bf16 v[32:35], v[200:203], v[96:99], v[32:35]
    v_mfma_f32_16x16x32_bf16 v[64:67], v[204:207], v[96:99], v[64:67]
    ds_read_b128 v[96:99], v248 offset:28672
    v_mfma_f32_16x16x32_bf16 v[36:39], v[200:203], v[100:103], v[36:39]
    v_mfma_f32_16x16x32_bf16 v[68:71], v[204:207], v[100:103], v[68:71]
    ds_read_b128 v[100:103], v248 offset:30720
    s_cmp_lg_u32 s3, 0
    s_cbranch_scc1 L_ct8
    buffer_load_dword v209, v208, s[72:75], s9 offen offset:4 sc1
L_ct8:
    ds_read_b128 v[200:203], v251 offset:0
    ds_read_b128 v[204:207], v251 offset:2048
    s_waitcnt lgkmcnt(9)
    v_mfma_f32_16x16x32_bf16 v[8:11], v[192:195], v[72:75], v[8:11]
    v_mfma_f32_16x16x32_bf16 v[40:43], v[196:199], v[72:75], v[40:43]
    ds_read_b128 v[72:75], v249 offset:16384
    s_waitcnt lgkmcnt(9)
    v_mfma_f32_16x16x32_bf16 v[12:15], v[192:195], v[76:79], v[12:15]
    v_mfma_f32_16x16x32_bf16 v[44:47], v[196:199], v[76:79], v[44:47]
    ds_read_b128 v[76:79], v249 offset:18432
    s_waitcnt lgkmcnt(9)
    v_mfma_f32_16x16x32_bf16 v[16:19], v[192:195], v[80:83], v[16:19]
    v_mfma_f32_16x16x32_bf16 v[48:51], v[196:199], v[80:83], v[48:51]
    ds_read_b128 v[80:83], v249 offset:20480
    s_waitcnt lgkmcnt(9)
    v_mfma_f32_16x16x32_bf16 v[20:23], v[192:195], v[84:87], v[20:23]
    v_mfma_f32_16x16x32_bf16 v[52:55], v[196:199], v[84:87], v[52:55]
    ds_read_b128 v[84:87], v249 offset:22528
    s_waitcnt lgkmcnt(9)
    v_mfma_f32_16x16x32_bf16 v[24:27], v[192:195], v[88:91], v[24:27]
    v_mfma_f32_16x16x32_bf16 v[56:59], v[196:199], v[88:91], v[56:59]
    ds_read_b128 v[88:91], v249 offset:24576
    s_waitcnt lgkmcnt(9)
    v_mfma_f32_16x16x32_bf16 v[28:31], v[192:195], v[92:95], v[28:31]
    v_mfma_f32_16x16x32_bf16 v[60:63], v[196:199], v[92:95], v[60:63]
    ds_read_b128 v[92:95], v249 offset:26624
    s_waitcnt lgkmcnt(9)
    v_mfma_f32_16x16x32_bf16 v[32:35], v[192:195], v[96:99], v[32:35]
    v_mfma_f32_16x16x32_bf16 v[64:67], v[196:199], v[96:99], v[64:67]
    ds_read_b128 v[96:99], v249 offset:28672
    s_waitcnt lgkmcnt(9)
    v_mfma_f32_16x16x32_bf16 v[36:39], v[192:195], v[100:103], v[36:39]
    v_mfma_f32_16x16x32_bf16 v[68:71], v[196:199], v[100:103], v[68:71]
    ds_read_b128 v[100:103], v249 offset:30720
    s_waitcnt lgkmcnt(7)
    v_mfma_f32_16x16x32_bf16 v[8:11], v[200:203], v[72:75], v[8:11]
    v_mfma_f32_16x16x32_bf16 v[40:43], v[204:207], v[72:75], v[40:43]
    s_waitcnt lgkmcnt(6)
    v_mfma_f32_16x16x32_bf16 v[12:15], v[200:203], v[76:79], v[12:15]
    v_mfma_f32_16x16x32_bf16 v[44:47], v[204:207], v[76:79], v[44:47]
    s_waitcnt lgkmcnt(0)
    s_barrier
    ds_read_b128 v[192:195], v250 offset:32768
    ds_read_b128 v[196:199], v250 offset:34816
    ds_read_b128 v[72:75], v248 offset:49152
    ds_read_b128 v[76:79], v248 offset:51200
    v_mfma_f32_16x16x32_bf16 v[16:19], v[200:203], v[80:83], v[16:19]
    v_mfma_f32_16x16x32_bf16 v[48:51], v[204:207], v[80:83], v[48:51]
    ds_read_b128 v[80:83], v248 offset:53248
    v_mfma_f32_16x16x32_bf16 v[20:23], v[200:203], v[84:87], v[20:23]
    v_mfma_f32_16x16x32_bf16 v[52:55], v[204:207], v[84:87], v[52:55]
    ds_read_b128 v[84:87], v248 offset:55296
    v_mfma_f32_16x16x32_bf16 v[24:27], v[200:203], v[88:91], v[24:27]
    v_mfma_f32_16x16x32_bf16 v[56:59], v[204:207], v[88:91], v[56:59]
    ds_read_b128 v[88:91], v248 offset:57344
    v_mfma_f32_16x16x32_bf16 v[28:31], v[200:203], v[92:95], v[28:31]
    v_mfma_f32_16x16x32_bf16 v[60:63], v[204:207], v[92:95], v[60:63]
    ds_read_b128 v[92:95], v248 offset:59392
    v_mfma_f32_16x16x32_bf16 v[32:35], v[200:203], v[96:99], v[32:35]
    v_mfma_f32_16x16x32_bf16 v[64:67], v[204:207], v[96:99], v[64:67]
    ds_read_b128 v[96:99], v248 offset:61440
    v_mfma_f32_16x16x32_bf16 v[36:39], v[200:203], v[100:103], v[36:39]
    v_mfma_f32_16x16x32_bf16 v[68:71], v[204:207], v[100:103], v[68:71]
    ds_read_b128 v[100:103], v248 offset:63488
    ds_read_b128 v[200:203], v251 offset:32768
    ds_read_b128 v[204:207], v251 offset:34816
    s_waitcnt lgkmcnt(9)
    v_mfma_f32_16x16x32_bf16 v[8:11], v[192:195], v[72:75], v[8:11]
    v_mfma_f32_16x16x32_bf16 v[40:43], v[196:199], v[72:75], v[40:43]
    ds_read_b128 v[72:75], v249 offset:49152
    s_waitcnt lgkmcnt(9)
    v_mfma_f32_16x16x32_bf16 v[12:15], v[192:195], v[76:79], v[12:15]
    v_mfma_f32_16x16x32_bf16 v[44:47], v[196:199], v[76:79], v[44:47]
    ds_read_b128 v[76:79], v249 offset:51200
    s_waitcnt lgkmcnt(9)
    v_mfma_f32_16x16x32_bf16 v[16:19], v[192:195], v[80:83], v[16:19]
    v_mfma_f32_16x16x32_bf16 v[48:51], v[196:199], v[80:83], v[48:51]
    ds_read_b128 v[80:83], v249 offset:53248
    s_waitcnt lgkmcnt(9)
    v_mfma_f32_16x16x32_bf16 v[20:23], v[192:195], v[84:87], v[20:23]
    v_mfma_f32_16x16x32_bf16 v[52:55], v[196:199], v[84:87], v[52:55]
    ds_read_b128 v[84:87], v249 offset:55296
    s_waitcnt lgkmcnt(9)
    v_mfma_f32_16x16x32_bf16 v[24:27], v[192:195], v[88:91], v[24:27]
    v_mfma_f32_16x16x32_bf16 v[56:59], v[196:199], v[88:91], v[56:59]
    ds_read_b128 v[88:91], v249 offset:57344
    s_waitcnt lgkmcnt(9)
    v_mfma_f32_16x16x32_bf16 v[28:31], v[192:195], v[92:95], v[28:31]
    v_mfma_f32_16x16x32_bf16 v[60:63], v[196:199], v[92:95], v[60:63]
    ds_read_b128 v[92:95], v249 offset:59392
    s_waitcnt lgkmcnt(9)
    v_mfma_f32_16x16x32_bf16 v[32:35], v[192:195], v[96:99], v[32:35]
    v_mfma_f32_16x16x32_bf16 v[64:67], v[196:199], v[96:99], v[64:67]
    ds_read_b128 v[96:99], v249 offset:61440
    s_waitcnt lgkmcnt(9)
    v_mfma_f32_16x16x32_bf16 v[36:39], v[192:195], v[100:103], v[36:39]
    v_mfma_f32_16x16x32_bf16 v[68:71], v[196:199], v[100:103], v[68:71]
    ds_read_b128 v[100:103], v249 offset:63488
    s_waitcnt lgkmcnt(7)
    v_mfma_f32_16x16x32_bf16 v[8:11], v[200:203], v[72:75], v[8:11]
    v_mfma_f32_16x16x32_bf16 v[40:43], v[204:207], v[72:75], v[40:43]
    s_waitcnt lgkmcnt(6)
    v_mfma_f32_16x16x32_bf16 v[12:15], v[200:203], v[76:79], v[12:15]
    v_mfma_f32_16x16x32_bf16 v[44:47], v[204:207], v[76:79], v[44:47]
    s_waitcnt lgkmcnt(0)
    s_barrier
    ds_read_b128 v[192:195], v254 offset:0
    ds_read_b128 v[196:199], v254 offset:2048
    ds_read_b128 v[72:75], v252 offset:16384
    ds_read_b128 v[76:79], v252 offset:18432
    v_mfma_f32_16x16x32_bf16 v[16:19], v[200:203], v[80:83], v[16:19]
    v_mfma_f32_16x16x32_bf16 v[48:51], v[204:207], v[80:83], v[48:51]
    ds_read_b128 v[80:83], v252 offset:20480
    v_mfma_f32_16x16x32_bf16 v[20:23], v[200:203], v[84:87], v[20:23]
    v_mfma_f32_16x16x32_bf16 v[52:55], v[204:207], v[84:87], v[52:55]
    ds_read_b128 v[84:87], v252 offset:22528
    v_mfma_f32_16x16x32_bf16 v[24:27], v[200:203], v[88:91], v[24:27]
    v_mfma_f32_16x16x32_bf16 v[56:59], v[204:207], v[88:91], v[56:59]
    ds_read_b128 v[88:91], v252 offset:24576
    v_mfma_f32_16x16x32_bf16 v[28:31], v[200:203], v[92:95], v[28:31]
    v_mfma_f32_16x16x32_bf16 v[60:63], v[204:207], v[92:95], v[60:63]
    ds_read_b128 v[92:95], v252 offset:26624
    v_mfma_f32_16x16x32_bf16 v[32:35], v[200:203], v[96:99], v[32:35]
    v_mfma_f32_16x16x32_bf16 v[64:67], v[204:207], v[96:99], v[64:67]
    ds_read_b128 v[96:99], v252 offset:28672
    v_mfma_f32_16x16x32_bf16 v[36:39], v[200:203], v[100:103], v[36:39]
    v_mfma_f32_16x16x32_bf16 v[68:71], v[204:207], v[100:103], v[68:71]
    ds_read_b128 v[100:103], v252 offset:30720
    s_cmp_lg_u32 s3, 0
    s_cbranch_scc1 L_ct12
    s_mov_b32 s6, 200000
L_tabw:
    s_waitcnt vmcnt(0)
    v_cmp_ne_u32 vcc, 0, v209
    s_cbranch_vccnz L_tabok
    buffer_load_dword v209, v208, s[72:75], s9 offen offset:4 sc1
    s_sub_u32 s6, s6, 1
    s_cbranch_scc0 L_tabw
L_tabok:
    s_lshl_b32 s6, s5, 13
    s_add_u32 s6, s6, 0x5a0000
    s_add_u32 s8, s6, 4096
    buffer_load_dwordx4 v[216:219], v1, s[60:63], s6 offen offset:0 sc1
    buffer_load_dwordx4 v[220:223], v1, s[60:63], s6 offen offset:1024 sc1
    buffer_load_dwordx4 v[224:227], v1, s[60:63], s6 offen offset:2048 sc1
    buffer_load_dwordx4 v[228:231], v1, s[60:63], s6 offen offset:3072 sc1
    buffer_load_dwordx4 v[232:235], v1, s[60:63], s8 offen offset:0 sc1
    buffer_load_dwordx4 v[236:239], v1, s[60:63], s8 offen offset:1024 sc1
L_ct12:
    ds_read_b128 v[200:203], v255 offset:0
    ds_read_b128 v[204:207], v255 offset:2048
    s_waitcnt lgkmcnt(9)
    v_mfma_f32_16x16x32_bf16 v[8:11], v[192:195], v[72:75], v[8:11]
    v_mfma_f32_16x16x32_bf16 v[40:43], v[196:199], v[72:75], v[40:43]
    ds_read_b128 v[72:75], v253 offset:16384
    s_waitcnt lgkmcnt(9)
    v_mfma_f32_16x16x32_bf16 v[12:15], v[192:195], v[76:79], v[12:15]
    v_mfma_f32_16x16x32_bf16 v[44:47], v[196:199], v[76:79], v[44:47]
    ds_read_b128 v[76:79], v253 offset:18432
    s_waitcnt lgkmcnt(9)
    v_mfma_f32_16x16x32_bf16 v[16:19], v[192:195], v[80:83], v[16:19]
    v_mfma_f32_16x16x32_bf16 v[48:51], v[196:199], v[80:83], v[48:51]
    ds_read_b128 v[80:83], v253 offset:20480
    s_waitcnt lgkmcnt(9)
    v_mfma_f32_16x16x32_bf16 v[20:23], v[192:195], v[84:87], v[20:23]
    v_mfma_f32_16x16x32_bf16 v[52:55], v[196:199], v[84:87], v[52:55]
    ds_read_b128 v[84:87], v253 offset:22528
    s_waitcnt lgkmcnt(9)
    v_mfma_f32_16x16x32_bf16 v[24:27], v[192:195], v[88:91], v[24:27]
    v_mfma_f32_16x16x32_bf16 v[56:59], v[196:199], v[88:91], v[56:59]
    ds_read_b128 v[88:91], v253 offset:24576
    s_waitcnt lgkmcnt(9)
    v_mfma_f32_16x16x32_bf16 v[28:31], v[192:195], v[92:95], v[28:31]
    v_mfma_f32_16x16x32_bf16 v[60:63], v[196:199], v[92:95], v[60:63]
    ds_read_b128 v[92:95], v253 offset:26624
    s_waitcnt lgkmcnt(9)
    v_mfma_f32_16x16x32_bf16 v[32:35], v[192:195], v[96:99], v[32:35]
    v_mfma_f32_16x16x32_bf16 v[64:67], v[196:199], v[96:99], v[64:67]
    ds_read_b128 v[96:99], v253 offset:28672
    s_waitcnt lgkmcnt(9)
    v_mfma_f32_16x16x32_bf16 v[36:39], v[192:195], v[100:103], v[36:39]
    v_mfma_f32_16x16x32_bf16 v[68:71], v[196:199], v[100:103], v[68:71]
    ds_read_b128 v[100:103], v253 offset:30720
    s_waitcnt lgkmcnt(7)
    v_mfma_f32_16x16x32_bf16 v[8:11], v[200:203], v[72:75], v[8:11]
    v_mfma_f32_16x16x32_bf16 v[40:43], v[204:207], v[72:75], v[40:43]
    s_waitcnt lgkmcnt(6)
    v_mfma_f32_16x16x32_bf16 v[12:15], v[200:203], v[76:79], v[12:15]
    v_mfma_f32_16x16x32_bf16 v[44:47], v[204:207], v[76:79], v[44:47]
    s_waitcnt lgkmcnt(0)
    s_barrier
    ds_read_b128 v[192:195], v254 offset:32768
    ds_read_b128 v[196:199], v254 offset:34816
    ds_read_b128 v[72:75], v252 offset:49152
    ds_read_b128 v[76:79], v252 offset:51200
    v_mfma_f32_16x16x32_bf16 v[16:19], v[200:203], v[80:83], v[16:19]
    v_mfma_f32_16x16x32_bf16 v[48:51], v[204:207], v[80:83], v[48:51]
    ds_read_b128 v[80:83], v252 offset:53248
    v_mfma_f32_16x16x32_bf16 v[20:23], v[200:203], v[84:87], v[20:23]
    v_mfma_f32_16x16x32_bf16 v[52:55], v[204:207], v[84:87], v[52:55]
    ds_read_b128 v[84:87], v252 offset:55296
    v_mfma_f32_16x16x32_bf16 v[24:27], v[200:203], v[88:91], v[24:27]
    v_mfma_f32_16x16x32_bf16 v[56:59], v[204:207], v[88:91], v[56:59]
    ds_read_b128 v[88:91], v252 offset:57344
    v_mfma_f32_16x16x32_bf16 v[28:31], v[200:203], v[92:95], v[28:31]
    v_mfma_f32_16x16x32_bf16 v[60:63], v[204:207], v[92:95], v[60:63]
    ds_read_b128 v[92:95], v252 offset:59392
    v_mfma_f32_16x16x32_bf16 v[32:35], v[200:203], v[96:99], v[32:35]
    v_mfma_f32_16x16x32_bf16 v[64:67], v[204:207], v[96:99], v[64:67]
    ds_read_b128 v[96:99], v252 offset:61440
    v_mfma_f32_16x16x32_bf16 v[36:39], v[200:203], v[100:103], v[36:39]
    v_mfma_f32_16x16x32_bf16 v[68:71], v[204:207], v[100:103], v[68:71]
    ds_read_b128 v[100:103], v252 offset:63488
    s_cmp_lg_u32 s3, 0
    s_cbranch_scc1 L_ct14
    s_waitcnt vmcnt(0)
    ds_write_b128 v210, v[216:219] offset:0
    ds_write_b128 v210, v[220:223] offset:4096
    ds_write_b128 v210, v[224:227] offset:8192
    ds_write_b128 v210, v[228:231] offset:12288
    ds_write_b128 v210, v[232:235] offset:1024
    ds_write_b128 v211, v[236:239]
L_ct14:
    ds_read_b128 v[200:203], v255 offset:32768
    ds_read_b128 v[204:207], v255 offset:34816
    s_waitcnt lgkmcnt(9)
    v_mfma_f32_16x16x32_bf16 v[8:11], v[192:195], v[72:75], v[8:11]
    v_mfma_f32_16x16x32_bf16 v[40:43], v[196:199], v[72:75], v[40:43]
    ds_read_b128 v[72:75], v253 offset:49152
    s_waitcnt lgkmcnt(9)
    v_mfma_f32_16x16x32_bf16 v[12:15], v[192:195], v[76:79], v[12:15]
    v_mfma_f32_16x16x32_bf16 v[44:47], v[196:199], v[76:79], v[44:47]
    ds_read_b128 v[76:79], v253 offset:51200
    s_waitcnt lgkmcnt(9)
    v_mfma_f32_16x16x32_bf16 v[16:19], v[192:195], v[80:83], v[16:19]
    v_mfma_f32_16x16x32_bf16 v[48:51], v[196:199], v[80:83], v[48:51]
    ds_read_b128 v[80:83], v253 offset:53248
    s_waitcnt lgkmcnt(9)
    v_mfma_f32_16x16x32_bf16 v[20:23], v[192:195], v[84:87], v[20:23]
    v_mfma_f32_16x16x32_bf16 v[52:55], v[196:199], v[84:87], v[52:55]
    ds_read_b128 v[84:87], v253 offset:55296
    s_waitcnt lgkmcnt(9)
    v_mfma_f32_16x16x32_bf16 v[24:27], v[192:195], v[88:91], v[24:27]
    v_mfma_f32_16x16x32_bf16 v[56:59], v[196:199], v[88:91], v[56:59]
    ds_read_b128 v[88:91], v253 offset:57344
    s_waitcnt lgkmcnt(9)
    v_mfma_f32_16x16x32_bf16 v[28:31], v[192:195], v[92:95], v[28:31]
    v_mfma_f32_16x16x32_bf16 v[60:63], v[196:199], v[92:95], v[60:63]
    ds_read_b128 v[92:95], v253 offset:59392
    s_waitcnt lgkmcnt(9)
    v_mfma_f32_16x16x32_bf16 v[32:35], v[192:195], v[96:99], v[32:35]
    v_mfma_f32_16x16x32_bf16 v[64:67], v[196:199], v[96:99], v[64:67]
    ds_read_b128 v[96:99], v253 offset:61440
    s_waitcnt lgkmcnt(9)
    v_mfma_f32_16x16x32_bf16 v[36:39], v[192:195], v[100:103], v[36:39]
    v_mfma_f32_16x16x32_bf16 v[68:71], v[196:199], v[100:103], v[68:71]
    ds_read_b128 v[100:103], v253 offset:63488
    s_waitcnt lgkmcnt(7)
    v_mfma_f32_16x16x32_bf16 v[8:11], v[200:203], v[72:75], v[8:11]
    v_mfma_f32_16x16x32_bf16 v[40:43], v[204:207], v[72:75], v[40:43]
    s_waitcnt lgkmcnt(6)
    v_mfma_f32_16x16x32_bf16 v[12:15], v[200:203], v[76:79], v[12:15]
    v_mfma_f32_16x16x32_bf16 v[44:47], v[204:207], v[76:79], v[44:47]
    s_waitcnt lgkmcnt(0)
    s_barrier
    ds_read_b128 v[192:195], v250 offset:0
    ds_read_b128 v[196:199], v250 offset:2048
    ds_read_b128 v[72:75], v248 offset:16384
    ds_read_b128 v[76:79], v248 offset:18432
    v_mfma_f32_16x16x32_bf16 v[16:19], v[200:203], v[80:83], v[16:19]
    v_mfma_f32_16x16x32_bf16 v[48:51], v[204:207], v[80:83], v[48:51]
    ds_read_b128 v[80:83], v248 offset:20480
    v_mfma_f32_16x16x32_bf16 v[20:23], v[200:203], v[84:87], v[20:23]
    v_mfma_f32_16x16x32_bf16 v[52:55], v[204:207], v[84:87], v[52:55]
    ds_read_b128 v[84:87], v248 offset:22528
    v_mfma_f32_16x16x32_bf16 v[24:27], v[200:203], v[88:91], v[24:27]
    v_mfma_f32_16x16x32_bf16 v[56:59], v[204:207], v[88:91], v[56:59]
    ds_read_b128 v[88:91], v248 offset:24576
    v_mfma_f32_16x16x32_bf16 v[28:31], v[200:203], v[92:95], v[28:31]
    v_mfma_f32_16x16x32_bf16 v[60:63], v[204:207], v[92:95], v[60:63]
    ds_read_b128 v[92:95], v248 offset:26624
    v_mfma_f32_16x16x32_bf16 v[32:35], v[200:203], v[96:99], v[32:35]
    v_mfma_f32_16x16x32_bf16 v[64:67], v[204:207], v[96:99], v[64:67]
    ds_read_b128 v[96:99], v248 offset:28672
    v_mfma_f32_16x16x32_bf16 v[36:39], v[200:203], v[100:103], v[36:39]
    v_mfma_f32_16x16x32_bf16 v[68:71], v[204:207], v[100:103], v[68:71]
    ds_read_b128 v[100:103], v248 offset:30720
    ds_read_b128 v[200:203], v251 offset:0
    ds_read_b128 v[204:207], v251 offset:2048
    s_waitcnt lgkmcnt(9)
    v_mfma_f32_16x16x32_bf16 v[8:11], v[192:195], v[72:75], v[8:11]
    v_mfma_f32_16x16x32_bf16 v[40:43], v[196:199], v[72:75], v[40:43]
    ds_read_b128 v[72:75], v249 offset:16384
    ds_read_b128 v[168:171], v6 offset:1024
    s_waitcnt lgkmcnt(10)
    v_mfma_f32_16x16x32_bf16 v[12:15], v[192:195], v[76:79], v[12:15]
    v_mfma_f32_16x16x32_bf16 v[44:47], v[196:199], v[76:79], v[44:47]
    ds_read_b128 v[76:79], v249 offset:18432
    ds_read_b128 v[172:175], v6 offset:1280
    s_waitcnt lgkmcnt(11)
    v_mfma_f32_16x16x32_bf16 v[16:19], v[192:195], v[80:83], v[16:19]
    v_mfma_f32_16x16x32_bf16 v[48:51], v[196:199], v[80:83], v[48:51]
    ds_read_b128 v[80:83], v249 offset:20480
    ds_read_b128 v[176:179], v6 offset:1536
    s_waitcnt lgkmcnt(12)
    v_mfma_f32_16x16x32_bf16 v[20:23], v[192:195], v[84:87], v[20:23]
    v_mfma_f32_16x16x32_bf16 v[52:55], v[196:199], v[84:87], v[52:55]
    ds_read_b128 v[84:87], v249 offset:22528
    ds_read_b128 v[180:183], v6 offset:1792
    s_waitcnt lgkmcnt(13)
    v_mfma_f32_16x16x32_bf16 v[24:27], v[192:195], v[88:91], v[24:27]
    v_mfma_f32_16x16x32_bf16 v[56:59], v[196:199], v[88:91], v[56:59]
    ds_read_b128 v[88:91], v249 offset:24576
    ds_read_b64 v[184:185], v7 offset:0
    s_waitcnt lgkmcnt(14)
    v_mfma_f32_16x16x32_bf16 v[28:31], v[192:195], v[92:95], v[28:31]
    v_mfma_f32_16x16x32_bf16 v[60:63], v[196:199], v[92:95], v[60:63]
    ds_read_b128 v[92:95], v249 offset:26624
    ds_read_b64 v[186:187], v7 offset:128
    s_waitcnt lgkmcnt(15)
    v_mfma_f32_16x16x32_bf16 v[32:35], v[192:195], v[96:99], v[32:35]
    v_mfma_f32_16x16x32_bf16 v[64:67], v[196:199], v[96:99], v[64:67]
    ds_read_b128 v[96:99], v249 offset:28672
    ds_read_b64 v[188:189], v7 offset:256
    s_waitcnt lgkmcnt(15)
    v_mfma_f32_16x16x32_bf16 v[36:39], v[192:195], v[100:103], v[36:39]
    v_mfma_f32_16x16x32_bf16 v[68:71], v[196:199], v[100:103], v[68:71]
    ds_read_b128 v[100:103], v249 offset:30720
    ds_read_b64 v[190:191], v7 offset:384
    s_waitcnt lgkmcnt(15)
    v_mfma_f32_16x16x32_bf16 v[8:11], v[200:203], v[72:75], v[8:11]
    v_mfma_f32_16x16x32_bf16 v[40:43], v[204:207], v[72:75], v[40:43]
    ds_read_b128 v[104:107], v6 offset:0
    ds_read_b128 v[108:111], v6 offset:256
    s_waitcnt lgkmcnt(15)
    v_mfma_f32_16x16x32_bf16 v[12:15], v[200:203], v[76:79], v[12:15]
    v_mfma_f32_16x16x32_bf16 v[44:47], v[204:207], v[76:79], v[44:47]
    ds_read_b128 v[112:115], v6 offset:512
    ds_read_b128 v[116:119], v6 offset:768
    s_waitcnt lgkmcnt(15)
    v_mfma_f32_16x16x32_bf16 v[16:19], v[200:203], v[80:83], v[16:19]
    v_mfma_f32_16x16x32_bf16 v[48:51], v[204:207], v[80:83], v[48:51]
    ds_read_b128 v[120:123], v6 offset:4096
    ds_read_b128 v[124:127], v6 offset:4352
    s_waitcnt lgkmcnt(15)
    v_mfma_f32_16x16x32_bf16 v[20:23], v[200:203], v[84:87], v[20:23]
    v_mfma_f32_16x16x32_bf16 v[52:55], v[204:207], v[84:87], v[52:55]
    ds_read_b128 v[128:131], v6 offset:4608
    ds_read_b128 v[132:135], v6 offset:4864
    s_waitcnt lgkmcnt(15)
    v_mfma_f32_16x16x32_bf16 v[24:27], v[200:203], v[88:91], v[24:27]
    v_mfma_f32_16x16x32_bf16 v[56:59], v[204:207], v[88:91], v[56:59]
    ds_read_b128 v[136:139], v6 offset:8192
    ds_read_b128 v[140:143], v6 offset:8448
    s_waitcnt lgkmcnt(15)
    v_mfma_f32_16x16x32_bf16 v[28:31], v[200:203], v[92:95], v[28:31]
    v_mfma_f32_16x16x32_bf16 v[60:63], v[204:207], v[92:95], v[60:63]
    ds_read_b128 v[144:147], v6 offset:8704
    ds_read_b128 v[148:151], v6 offset:8960
    s_waitcnt lgkmcnt(15)
    v_mfma_f32_16x16x32_bf16 v[32:35], v[200:203], v[96:99], v[32:35]
    v_mfma_f32_16x16x32_bf16 v[64:67], v[204:207], v[96:99], v[64:67]
    ds_read_b128 v[152:155], v6 offset:12288
    ds_read_b128 v[156:159], v6 offset:12544
    s_waitcnt lgkmcnt(15)
    v_mfma_f32_16x16x32_bf16 v[36:39], v[200:203], v[100:103], v[36:39]
    v_mfma_f32_16x16x32_bf16 v[68:71], v[204:207], v[100:103], v[68:71]
    ds_read_b128 v[160:163], v6 offset:12800
    ds_read_b128 v[164:167], v6 offset:13056
    v_pk_fma_f32 v[10:11], v[168:169], v[8:9], v[10:11] op_sel:[0,0,0] op_sel_hi:[0,1,1]
    v_pk_fma_f32 v[26:27], v[168:169], v[24:25], v[26:27] op_sel:[0,0,0] op_sel_hi:[0,1,1]
    v_pk_fma_f32 v[10:11], v[168:169], v[24:25], v[10:11] op_sel:[1,0,0] op_sel_hi:[1,1,1] neg_lo:[1,0,0] neg_hi:[1,0,0]
    v_pk_fma_f32 v[26:27], v[168:169], v[8:9], v[26:27] op_sel:[1,0,0] op_sel_hi:[1,1,1]
    v_pk_fma_f32 v[40:41], v[168:169], v[10:11], v[40:41] op_sel:[0,0,0] op_sel_hi:[0,1,1]
    v_pk_fma_f32 v[56:57], v[168:169], v[26:27], v[56:57] op_sel:[0,0,0] op_sel_hi:[0,1,1]
    v_pk_fma_f32 v[40:41], v[168:169], v[26:27], v[40:41] op_sel:[1,0,0] op_sel_hi:[1,1,1] neg_lo:[1,0,0] neg_hi:[1,0,0]
    v_pk_fma_f32 v[56:57], v[168:169], v[10:11], v[56:57] op_sel:[1,0,0] op_sel_hi:[1,1,1]
    v_pk_fma_f32 v[42:43], v[168:169], v[40:41], v[42:43] op_sel:[0,0,0] op_sel_hi:[0,1,1]
    v_pk_fma_f32 v[58:59], v[168:169], v[56:57], v[58:59] op_sel:[0,0,0] op_sel_hi:[0,1,1]
    v_pk_fma_f32 v[42:43], v[168:169], v[56:57], v[42:43] op_sel:[1,0,0] op_sel_hi:[1,1,1] neg_lo:[1,0,0] neg_hi:[1,0,0]
    v_pk_fma_f32 v[58:59], v[168:169], v[40:41], v[58:59] op_sel:[1,0,0] op_sel_hi:[1,1,1]
    v_fma_f32 v72, v170, v42, v43
    v_fma_f32 v73, v170, v58, v59
    v_fma_f32 v72, -v171, v58, v72
    v_fma_f32 v73, v171, v42, v73
    v_pk_fma_f32 v[14:15], v[172:173], v[12:13], v[14:15] op_sel:[0,0,0] op_sel_hi:[0,1,1]
    v_pk_fma_f32 v[30:31], v[172:173], v[28:29], v[30:31] op_sel:[0,0,0] op_sel_hi:[0,1,1]
    v_pk_fma_f32 v[14:15], v[172:173], v[28:29], v[14:15] op_sel:[1,0,0] op_sel_hi:[1,1,1] neg_lo:[1,0,0] neg_hi:[1,0,0]
    v_pk_fma_f32 v[30:31], v[172:173], v[12:13], v[30:31] op_sel:[1,0,0] op_sel_hi:[1,1,1]
    v_pk_fma_f32 v[44:45], v[172:173], v[14:15], v[44:45] op_sel:[0,0,0] op_sel_hi:[0,1,1]
    v_pk_fma_f32 v[60:61], v[172:173], v[30:31], v[60:61] op_sel:[0,0,0] op_sel_hi:[0,1,1]
    v_pk_fma_f32 v[44:45], v[172:173], v[30:31], v[44:45] op_sel:[1,0,0] op_sel_hi:[1,1,1] neg_lo:[1,0,0] neg_hi:[1,0,0]
    v_pk_fma_f32 v[60:61], v[172:173], v[14:15], v[60:61] op_sel:[1,0,0] op_sel_hi:[1,1,1]
    v_pk_fma_f32 v[46:47], v[172:173], v[44:45], v[46:47] op_sel:[0,0,0] op_sel_hi:[0,1,1]
    v_pk_fma_f32 v[62:63], v[172:173], v[60:61], v[62:63] op_sel:[0,0,0] op_sel_hi:[0,1,1]
    v_pk_fma_f32 v[46:47], v[172:173], v[60:61], v[46:47] op_sel:[1,0,0] op_sel_hi:[1,1,1] neg_lo:[1,0,0] neg_hi:[1,0,0]
    v_pk_fma_f32 v[62:63], v[172:173], v[44:45], v[62:63] op_sel:[1,0,0] op_sel_hi:[1,1,1]
    v_fma_f32 v74, v174, v46, v47
    v_fma_f32 v75, v174, v62, v63
    v_fma_f32 v74, -v175, v62, v74
    v_fma_f32 v75, v175, v46, v75
    ds_write_b128 v2, v[72:75] offset:0
    v_pk_fma_f32 v[18:19], v[176:177], v[16:17], v[18:19] op_sel:[0,0,0] op_sel_hi:[0,1,1]
    v_pk_fma_f32 v[34:35], v[176:177], v[32:33], v[34:35] op_sel:[0,0,0] op_sel_hi:[0,1,1]
    v_pk_fma_f32 v[18:19], v[176:177], v[32:33], v[18:19] op_sel:[1,0,0] op_sel_hi:[1,1,1] neg_lo:[1,0,0] neg_hi:[1,0,0]
    v_pk_fma_f32 v[34:35], v[176:177], v[16:17], v[34:35] op_sel:[1,0,0] op_sel_hi:[1,1,1]
    v_pk_fma_f32 v[48:49], v[176:177], v[18:19], v[48:49] op_sel:[0,0,0] op_sel_hi:[0,1,1]
    v_pk_fma_f32 v[64:65], v[176:177], v[34:35], v[64:65] op_sel:[0,0,0] op_sel_hi:[0,1,1]
    v_pk_fma_f32 v[48:49], v[176:177], v[34:35], v[48:49] op_sel:[1,0,0] op_sel_hi:[1,1,1] neg_lo:[1,0,0] neg_hi:[1,0,0]
    v_pk_fma_f32 v[64:65], v[176:177], v[18:19], v[64:65] op_sel:[1,0,0] op_sel_hi:[1,1,1]
    v_pk_fma_f32 v[50:51], v[176:177], v[48:49], v[50:51] op_sel:[0,0,0] op_sel_hi:[0,1,1]
    v_pk_fma_f32 v[66:67], v[176:177], v[64:65], v[66:67] op_sel:[0,0,0] op_sel_hi:[0,1,1]
    v_pk_fma_f32 v[50:51], v[176:177], v[64:65], v[50:51] op_sel:[1,0,0] op_sel_hi:[1,1,1] neg_lo:[1,0,0] neg_hi:[1,0,0]
    v_pk_fma_f32 v[66:67], v[176:177], v[48:49], v[66:67] op_sel:[1,0,0] op_sel_hi:[1,1,1]
    v_fma_f32 v76, v178, v50, v51
    v_fma_f32 v77, v178, v66, v67
    v_fma_f32 v76, -v179, v66, v76
    v_fma_f32 v77, v179, v50, v77
    v_pk_fma_f32 v[22:23], v[180:181], v[20:21], v[22:23] op_sel:[0,0,0] op_sel_hi:[0,1,1]
    v_pk_fma_f32 v[38:39], v[180:181], v[36:37], v[38:39] op_sel:[0,0,0] op_sel_hi:[0,1,1]
    v_pk_fma_f32 v[22:23], v[180:181], v[36:37], v[22:23] op_sel:[1,0,0] op_sel_hi:[1,1,1] neg_lo:[1,0,0] neg_hi:[1,0,0]
    v_pk_fma_f32 v[38:39], v[180:181], v[20:21], v[38:39] op_sel:[1,0,0] op_sel_hi:[1,1,1]
    v_pk_fma_f32 v[52:53], v[180:181], v[22:23], v[52:53] op_sel:[0,0,0] op_sel_hi:[0,1,1]
    v_pk_fma_f32 v[68:69], v[180:181], v[38:39], v[68:69] op_sel:[0,0,0] op_sel_hi:[0,1,1]
    v_pk_fma_f32 v[52:53], v[180:181], v[38:39], v[52:53] op_sel:[1,0,0] op_sel_hi:[1,1,1] neg_lo:[1,0,0] neg_hi:[1,0,0]
    v_pk_fma_f32 v[68:69], v[180:181], v[22:23], v[68:69] op_sel:[1,0,0] op_sel_hi:[1,1,1]
    v_pk_fma_f32 v[54:55], v[180:181], v[52:53], v[54:55] op_sel:[0,0,0] op_sel_hi:[0,1,1]
    v_pk_fma_f32 v[70:71], v[180:181], v[68:69], v[70:71] op_sel:[0,0,0] op_sel_hi:[0,1,1]
    v_pk_fma_f32 v[54:55], v[180:181], v[68:69], v[54:55] op_sel:[1,0,0] op_sel_hi:[1,1,1] neg_lo:[1,0,0] neg_hi:[1,0,0]
    v_pk_fma_f32 v[70:71], v[180:181], v[52:53], v[70:71] op_sel:[1,0,0] op_sel_hi:[1,1,1]
    v_fma_f32 v78, v182, v54, v55
    v_fma_f32 v79, v182, v70, v71
    v_fma_f32 v78, -v183, v70, v78
    v_fma_f32 v79, v183, v54, v79
    ds_write_b128 v2, v[76:79] offset:16
    v_mov_b32 v254, 159232
    v_mov_b32 v255, 1
    s_mov_b64 exec, 1
    ds_add_u32 v254, v255 offset:12
    s_mov_b64 exec, -1
    s_waitcnt lgkmcnt(0)
    v_lshl_add_u32 v100, v5, 3, s10
    v_mul_u32_u24 v100, 1152, v100
    v_lshl_add_u32 v100, v4, 3, v100
    s_lshl_b32 s8, s5, 7
    s_add_u32 s9, s8, 4608
    v_lshlrev_b32 v101, 3, v4
    buffer_load_dwordx2 v[192:193], v100, s[56:59], s8 offen offset:0
    buffer_load_dwordx2 v[194:195], v100, s[56:59], s8 offen offset:1152
    buffer_load_dwordx2 v[196:197], v100, s[56:59], s8 offen offset:2304
    buffer_load_dwordx2 v[198:199], v100, s[56:59], s8 offen offset:3456
    buffer_load_dwordx2 v[200:201], v100, s[56:59], s9 offen offset:0
    buffer_load_dwordx2 v[202:203], v100, s[56:59], s9 offen offset:1152
    buffer_load_dwordx2 v[204:205], v100, s[56:59], s9 offen offset:2304
    buffer_load_dwordx2 v[206:207], v100, s[56:59], s9 offen offset:3456
    buffer_load_dwordx2 v[208:209], v101, s[68:71], s8 offen
    s_mov_b32 s11, s3
    v_lshl_add_u32 v6, v5, 3, s10
    v_mul_u32_u24 v3, 4608, v6
    v_lshl_add_u32 v3, v4, 4, v3
    s_lshl_b32 s8, s4, 2
    s_add_u32 s8, s8, s11
    s_mul_i32 s12, s8, 73856
    s_add_u32 s13, s12, 36864
    s_lshl_b32 s8, s5, 12
    s_add_u32 s14, s12, s8
    s_add_u32 s15, s13, s8
    v_lshrrev_b32 v6, 1, v4
    v_lshlrev_b32 v7, 2, v5
    v_xor_b32 v7, v6, v7
    v_lshlrev_b32 v7, 4, v7
    v_lshl_add_u32 v7, v6, 8, v7
    v_and_b32 v6, 1, v4
    v_lshl_add_u32 v7, v6, 3, v7
    v_add_u32 v210, s79, v7
    v_xor_b32 v211, 16, v210
    v_xor_b32 v212, 32, v210
    v_xor_b32 v213, 48, v210
    v_xor_b32 v6, v4, v5
    v_lshlrev_b32 v6, 4, v6
    v_lshl_add_u32 v6, v5, 8, v6
    v_add_u32 v214, s79, v6
    v_xor_b32 v215, 64, v214
    v_add_u32 v250, 0x20000, v248
    v_add_u32 v251, 0x20000, v249
    v_lshrrev_b32 v6, 1, v5
    v_lshlrev_b32 v6, 12, v6
    v_and_b32 v7, 1, v5
    v_lshl_add_u32 v6, v7, 9, v6
    v_lshl_add_u32 v6, v4, 5, v6
    v_add_u32 v252, 149504, v6
    s_lshr_b32 s8, s3, 1
    s_lshl_b32 s8, s8, 12
    s_and_b32 s9, s3, 1
    s_lshl_b32 s9, s9, 9
    s_add_u32 s8, s8, s9
    s_add_u32 s8, s8, 157696
    v_lshl_add_u32 v253, v4, 5, s8
    v_mov_b32 v80, v42
    v_mov_b32 v81, v58
    v_mov_b32 v82, v46
    v_mov_b32 v83, v62
    v_mov_b32 v84, v50
    v_mov_b32 v85, v66
    v_mov_b32 v86, v54
    v_mov_b32 v87, v70
    s_waitcnt lgkmcnt(0)
    v_pk_mul_f32 v[88:89], v[184:185], v[8:9] op_sel:[1,0] op_sel_hi:[1,1]
    v_pk_mul_f32 v[8:9], v[8:9], v[184:185] op_sel:[0,0] op_sel_hi:[1,0]
    v_pk_fma_f32 v[8:9], v[184:185], v[24:25], v[8:9] op_sel:[1,0,0] op_sel_hi:[1,1,1] neg_lo:[1,0,0] neg_hi:[1,0,0]
    v_pk_fma_f32 v[24:25], v[184:185], v[24:25], v[88:89] op_sel:[0,0,0] op_sel_hi:[0,1,1]
    v_pk_mul_f32 v[90:91], v[186:187], v[12:13] op_sel:[1,0] op_sel_hi:[1,1]
    v_pk_mul_f32 v[12:13], v[12:13], v[186:187] op_sel:[0,0] op_sel_hi:[1,0]
    v_pk_fma_f32 v[12:13], v[186:187], v[28:29], v[12:13] op_sel:[1,0,0] op_sel_hi:[1,1,1] neg_lo:[1,0,0] neg_hi:[1,0,0]
    v_pk_fma_f32 v[28:29], v[186:187], v[28:29], v[90:91] op_sel:[0,0,0] op_sel_hi:[0,1,1]
    v_pk_mul_f32 v[92:93], v[188:189], v[16:17] op_sel:[1,0] op_sel_hi:[1,1]
    v_pk_mul_f32 v[16:17], v[16:17], v[188:189] op_sel:[0,0] op_sel_hi:[1,0]
    v_pk_fma_f32 v[16:17], v[188:189], v[32:33], v[16:17] op_sel:[1,0,0] op_sel_hi:[1,1,1] neg_lo:[1,0,0] neg_hi:[1,0,0]
    v_pk_fma_f32 v[32:33], v[188:189], v[32:33], v[92:93] op_sel:[0,0,0] op_sel_hi:[0,1,1]
    v_pk_mul_f32 v[94:95], v[190:191], v[20:21] op_sel:[1,0] op_sel_hi:[1,1]
    v_pk_mul_f32 v[20:21], v[20:21], v[190:191] op_sel:[0,0] op_sel_hi:[1,0]
    v_pk_fma_f32 v[20:21], v[190:191], v[36:37], v[20:21] op_sel:[1,0,0] op_sel_hi:[1,1,1] neg_lo:[1,0,0] neg_hi:[1,0,0]
    v_pk_fma_f32 v[36:37], v[190:191], v[36:37], v[94:95] op_sel:[0,0,0] op_sel_hi:[0,1,1]
    v_pk_mul_f32 v[88:89], v[184:185], v[10:11] op_sel:[1,0] op_sel_hi:[1,1]
    v_pk_mul_f32 v[10:11], v[10:11], v[184:185] op_sel:[0,0] op_sel_hi:[1,0]
    v_pk_fma_f32 v[10:11], v[184:185], v[26:27], v[10:11] op_sel:[1,0,0] op_sel_hi:[1,1,1] neg_lo:[1,0,0] neg_hi:[1,0,0]
    v_pk_fma_f32 v[26:27], v[184:185], v[26:27], v[88:89] op_sel:[0,0,0] op_sel_hi:[0,1,1]
    v_pk_mul_f32 v[90:91], v[186:187], v[14:15] op_sel:[1,0] op_sel_hi:[1,1]
    v_pk_mul_f32 v[14:15], v[14:15], v[186:187] op_sel:[0,0] op_sel_hi:[1,0]
    v_pk_fma_f32 v[14:15], v[186:187], v[30:31], v[14:15] op_sel:[1,0,0] op_sel_hi:[1,1,1] neg_lo:[1,0,0] neg_hi:[1,0,0]
    v_pk_fma_f32 v[30:31], v[186:187], v[30:31], v[90:91] op_sel:[0,0,0] op_sel_hi:[0,1,1]
    v_pk_mul_f32 v[92:93], v[188:189], v[18:19] op_sel:[1,0] op_sel_hi:[1,1]
    v_pk_mul_f32 v[18:19], v[18:19], v[188:189] op_sel:[0,0] op_sel_hi:[1,0]
    v_pk_fma_f32 v[18:19], v[188:189], v[34:35], v[18:19] op_sel:[1,0,0] op_sel_hi:[1,1,1] neg_lo:[1,0,0] neg_hi:[1,0,0]
    v_pk_fma_f32 v[34:35], v[188:189], v[34:35], v[92:93] op_sel:[0,0,0] op_sel_hi:[0,1,1]
    v_pk_mul_f32 v[94:95], v[190:191], v[22:23] op_sel:[1,0] op_sel_hi:[1,1]
    v_pk_mul_f32 v[22:23], v[22:23], v[190:191] op_sel:[0,0] op_sel_hi:[1,0]
    v_pk_fma_f32 v[22:23], v[190:191], v[38:39], v[22:23] op_sel:[1,0,0] op_sel_hi:[1,1,1] neg_lo:[1,0,0] neg_hi:[1,0,0]
    v_pk_fma_f32 v[38:39], v[190:191], v[38:39], v[94:95] op_sel:[0,0,0] op_sel_hi:[0,1,1]
    v_pk_mul_f32 v[88:89], v[184:185], v[40:41] op_sel:[1,0] op_sel_hi:[1,1]
    v_pk_mul_f32 v[40:41], v[40:41], v[184:185] op_sel:[0,0] op_sel_hi:[1,0]
    v_pk_fma_f32 v[40:41], v[184:185], v[56:57], v[40:41] op_sel:[1,0,0] op_sel_hi:[1,1,1] neg_lo:[1,0,0] neg_hi:[1,0,0]
    v_pk_fma_f32 v[56:57], v[184:185], v[56:57], v[88:89] op_sel:[0,0,0] op_sel_hi:[0,1,1]
    v_pk_mul_f32 v[90:91], v[186:187], v[44:45] op_sel:[1,0] op_sel_hi:[1,1]
    v_pk_mul_f32 v[44:45], v[44:45], v[186:187] op_sel:[0,0] op_sel_hi:[1,0]
    v_pk_fma_f32 v[44:45], v[186:187], v[60:61], v[44:45] op_sel:[1,0,0] op_sel_hi:[1,1,1] neg_lo:[1,0,0] neg_hi:[1,0,0]
    v_pk_fma_f32 v[60:61], v[186:187], v[60:61], v[90:91] op_sel:[0,0,0] op_sel_hi:[0,1,1]
    v_pk_mul_f32 v[92:93], v[188:189], v[48:49] op_sel:[1,0] op_sel_hi:[1,1]
    v_pk_mul_f32 v[48:49], v[48:49], v[188:189] op_sel:[0,0] op_sel_hi:[1,0]
    v_pk_fma_f32 v[48:49], v[188:189], v[64:65], v[48:49] op_sel:[1,0,0] op_sel_hi:[1,1,1] neg_lo:[1,0,0] neg_hi:[1,0,0]
    v_pk_fma_f32 v[64:65], v[188:189], v[64:65], v[92:93] op_sel:[0,0,0] op_sel_hi:[0,1,1]
    v_pk_mul_f32 v[94:95], v[190:191], v[52:53] op_sel:[1,0] op_sel_hi:[1,1]
    v_pk_mul_f32 v[52:53], v[52:53], v[190:191] op_sel:[0,0] op_sel_hi:[1,0]
    v_pk_fma_f32 v[52:53], v[190:191], v[68:69], v[52:53] op_sel:[1,0,0] op_sel_hi:[1,1,1] neg_lo:[1,0,0] neg_hi:[1,0,0]
    v_pk_fma_f32 v[68:69], v[190:191], v[68:69], v[94:95] op_sel:[0,0,0] op_sel_hi:[0,1,1]
    v_pk_mul_f32 v[88:89], v[184:185], v[42:43] op_sel:[1,0] op_sel_hi:[1,1]
    v_pk_mul_f32 v[42:43], v[42:43], v[184:185] op_sel:[0,0] op_sel_hi:[1,0]
    v_pk_fma_f32 v[42:43], v[184:185], v[58:59], v[42:43] op_sel:[1,0,0] op_sel_hi:[1,1,1] neg_lo:[1,0,0] neg_hi:[1,0,0]
    v_pk_fma_f32 v[58:59], v[184:185], v[58:59], v[88:89] op_sel:[0,0,0] op_sel_hi:[0,1,1]
    v_pk_mul_f32 v[90:91], v[186:187], v[46:47] op_sel:[1,0] op_sel_hi:[1,1]
    v_pk_mul_f32 v[46:47], v[46:47], v[186:187] op_sel:[0,0] op_sel_hi:[1,0]
    v_pk_fma_f32 v[46:47], v[186:187], v[62:63], v[46:47] op_sel:[1,0,0] op_sel_hi:[1,1,1] neg_lo:[1,0,0] neg_hi:[1,0,0]
    v_pk_fma_f32 v[62:63], v[186:187], v[62:63], v[90:91] op_sel:[0,0,0] op_sel_hi:[0,1,1]
    v_pk_mul_f32 v[92:93], v[188:189], v[50:51] op_sel:[1,0] op_sel_hi:[1,1]
    v_pk_mul_f32 v[50:51], v[50:51], v[188:189] op_sel:[0,0] op_sel_hi:[1,0]
    v_pk_fma_f32 v[50:51], v[188:189], v[66:67], v[50:51] op_sel:[1,0,0] op_sel_hi:[1,1,1] neg_lo:[1,0,0] neg_hi:[1,0,0]
    v_pk_fma_f32 v[66:67], v[188:189], v[66:67], v[92:93] op_sel:[0,0,0] op_sel_hi:[0,1,1]
    v_pk_mul_f32 v[94:95], v[190:191], v[54:55] op_sel:[1,0] op_sel_hi:[1,1]
    v_pk_mul_f32 v[54:55], v[54:55], v[190:191] op_sel:[0,0] op_sel_hi:[1,0]
    v_pk_fma_f32 v[54:55], v[190:191], v[70:71], v[54:55] op_sel:[1,0,0] op_sel_hi:[1,1,1] neg_lo:[1,0,0] neg_hi:[1,0,0]
    v_pk_fma_f32 v[70:71], v[190:191], v[70:71], v[94:95] op_sel:[0,0,0] op_sel_hi:[0,1,1]
    v_fma_f32 v9, v104, v80, v9
    v_fma_f32 v25, v104, v81, v25
    v_fma_f32 v9, -v106, v81, v9
    v_fma_f32 v25, v106, v80, v25
    v_fma_f32 v13, v108, v82, v13
    v_fma_f32 v29, v108, v83, v29
    v_fma_f32 v13, -v110, v83, v13
    v_fma_f32 v29, v110, v82, v29
    v_fma_f32 v17, v112, v84, v17
    v_fma_f32 v33, v112, v85, v33
    v_fma_f32 v17, -v114, v85, v17
    v_fma_f32 v33, v114, v84, v33
    v_fma_f32 v21, v116, v86, v21
    v_fma_f32 v37, v116, v87, v37
    v_fma_f32 v21, -v118, v87, v21
    v_fma_f32 v37, v118, v86, v37
    v_fma_f32 v11, v120, v80, v11
    v_fma_f32 v27, v120, v81, v27
    v_fma_f32 v11, -v122, v81, v11
    v_fma_f32 v27, v122, v80, v27
    v_fma_f32 v15, v124, v82, v15
    v_fma_f32 v31, v124, v83, v31
    v_fma_f32 v15, -v126, v83, v15
    v_fma_f32 v31, v126, v82, v31
    v_fma_f32 v19, v128, v84, v19
    v_fma_f32 v35, v128, v85, v35
    v_fma_f32 v19, -v130, v85, v19
    v_fma_f32 v35, v130, v84, v35
    v_fma_f32 v23, v132, v86, v23
    v_fma_f32 v39, v132, v87, v39
    v_fma_f32 v23, -v134, v87, v23
    v_fma_f32 v39, v134, v86, v39
    v_fma_f32 v41, v136, v80, v41
    v_fma_f32 v57, v136, v81, v57
    v_fma_f32 v41, -v138, v81, v41
    v_fma_f32 v57, v138, v80, v57
    v_fma_f32 v45, v140, v82, v45
    v_fma_f32 v61, v140, v83, v61
    v_fma_f32 v45, -v142, v83, v45
    v_fma_f32 v61, v142, v82, v61
    v_fma_f32 v49, v144, v84, v49
    v_fma_f32 v65, v144, v85, v65
    v_fma_f32 v49, -v146, v85, v49
    v_fma_f32 v65, v146, v84, v65
    v_fma_f32 v53, v148, v86, v53
    v_fma_f32 v69, v148, v87, v69
    v_fma_f32 v53, -v150, v87, v53
    v_fma_f32 v69, v150, v86, v69
    v_fma_f32 v43, v152, v80, v43
    v_fma_f32 v59, v152, v81, v59
    v_fma_f32 v43, -v154, v81, v43
    v_fma_f32 v59, v154, v80, v59
    v_fma_f32 v47, v156, v82, v47
    v_fma_f32 v63, v156, v83, v63
    v_fma_f32 v47, -v158, v83, v47
    v_fma_f32 v63, v158, v82, v63
    v_fma_f32 v51, v160, v84, v51
    v_fma_f32 v67, v160, v85, v67
    v_fma_f32 v51, -v162, v85, v51
    v_fma_f32 v67, v162, v84, v67
    v_fma_f32 v55, v164, v86, v55
    v_fma_f32 v71, v164, v87, v71
    v_fma_f32 v55, -v166, v87, v55
    v_fma_f32 v71, v166, v86, v71
    v_mov_b32 v6, 159232
L_wait0:
    ds_read_b32 v7, v6 offset:8
    s_waitcnt lgkmcnt(0)
    v_cmp_eq_u32 vcc, 0, v7
    s_cbranch_vccnz L_wait0
    ds_read_b128 v[72:75], v2
    ds_read_b128 v[76:79], v2 offset:16
    ds_read_b128 v[80:83], v252
    ds_read_b128 v[84:87], v252 offset:16
    ds_read_b128 v[176:179], v253
    ds_read_b128 v[180:183], v253 offset:16
    v_lshlrev_b32 v7, 5, v4
    v_add_u32 v7, 162816, v7
    s_waitcnt vmcnt(0)
    v_lshlrev_b32 v88, 16, v208
    v_and_b32 v89, 0xffff0000, v208
    v_lshlrev_b32 v90, 16, v209
    v_and_b32 v91, 0xffff0000, v209
    v_lshlrev_b32 v96, 16, v192
    v_and_b32 v97, 0xffff0000, v192
    v_lshlrev_b32 v98, 16, v193
    v_and_b32 v99, 0xffff0000, v193
    v_pk_mul_f32 v[96:97], v[96:97], v[88:89]
    v_pk_mul_f32 v[98:99], v[98:99], v[90:91]
    v_cvt_pk_bf16_f32 v97, v96, v97
    v_cvt_pk_bf16_f32 v99, v98, v99
    v_lshlrev_b32 v216, 16, v97
    v_and_b32 v220, 0xffff0000, v97
    v_lshlrev_b32 v224, 16, v99
    v_and_b32 v228, 0xffff0000, v99
    v_lshlrev_b32 v100, 16, v194
    v_and_b32 v101, 0xffff0000, v194
    v_lshlrev_b32 v102, 16, v195
    v_and_b32 v103, 0xffff0000, v195
    v_pk_mul_f32 v[100:101], v[100:101], v[88:89]
    v_pk_mul_f32 v[102:103], v[102:103], v[90:91]
    v_cvt_pk_bf16_f32 v101, v100, v101
    v_cvt_pk_bf16_f32 v103, v102, v103
    v_lshlrev_b32 v217, 16, v101
    v_and_b32 v221, 0xffff0000, v101
    v_lshlrev_b32 v225, 16, v103
    v_and_b32 v229, 0xffff0000, v103
    v_lshlrev_b32 v96, 16, v196
    v_and_b32 v97, 0xffff0000, v196
    v_lshlrev_b32 v98, 16, v197
    v_and_b32 v99, 0xffff0000, v197
    v_pk_mul_f32 v[96:97], v[96:97], v[88:89]
    v_pk_mul_f32 v[98:99], v[98:99], v[90:91]
    v_cvt_pk_bf16_f32 v97, v96, v97
    v_cvt_pk_bf16_f32 v99, v98, v99
    v_lshlrev_b32 v218, 16, v97
    v_and_b32 v222, 0xffff0000, v97
    v_lshlrev_b32 v226, 16, v99
    v_and_b32 v230, 0xffff0000, v99
    v_lshlrev_b32 v100, 16, v198
    v_and_b32 v101, 0xffff0000, v198
    v_lshlrev_b32 v102, 16, v199
    v_and_b32 v103, 0xffff0000, v199
    v_pk_mul_f32 v[100:101], v[100:101], v[88:89]
    v_pk_mul_f32 v[102:103], v[102:103], v[90:91]
    v_cvt_pk_bf16_f32 v101, v100, v101
    v_cvt_pk_bf16_f32 v103, v102, v103
    v_lshlrev_b32 v219, 16, v101
    v_and_b32 v223, 0xffff0000, v101
    v_lshlrev_b32 v227, 16, v103
    v_and_b32 v231, 0xffff0000, v103
    v_lshlrev_b32 v96, 16, v200
    v_and_b32 v97, 0xffff0000, v200
    v_lshlrev_b32 v98, 16, v201
    v_and_b32 v99, 0xffff0000, v201
    v_pk_mul_f32 v[96:97], v[96:97], v[88:89]
    v_pk_mul_f32 v[98:99], v[98:99], v[90:91]
    v_cvt_pk_bf16_f32 v97, v96, v97
    v_cvt_pk_bf16_f32 v99, v98, v99
    v_lshlrev_b32 v232, 16, v97
    v_and_b32 v236, 0xffff0000, v97
    v_lshlrev_b32 v240, 16, v99
    v_and_b32 v244, 0xffff0000, v99
    v_lshlrev_b32 v100, 16, v202
    v_and_b32 v101, 0xffff0000, v202
    v_lshlrev_b32 v102, 16, v203
    v_and_b32 v103, 0xffff0000, v203
    v_pk_mul_f32 v[100:101], v[100:101], v[88:89]
    v_pk_mul_f32 v[102:103], v[102:103], v[90:91]
    v_cvt_pk_bf16_f32 v101, v100, v101
    v_cvt_pk_bf16_f32 v103, v102, v103
    v_lshlrev_b32 v233, 16, v101
    v_and_b32 v237, 0xffff0000, v101
    v_lshlrev_b32 v241, 16, v103
    v_and_b32 v245, 0xffff0000, v103
    v_lshlrev_b32 v96, 16, v204
    v_and_b32 v97, 0xffff0000, v204
    v_lshlrev_b32 v98, 16, v205
    v_and_b32 v99, 0xffff0000, v205
    v_pk_mul_f32 v[96:97], v[96:97], v[88:89]
    v_pk_mul_f32 v[98:99], v[98:99], v[90:91]
    v_cvt_pk_bf16_f32 v97, v96, v97
    v_cvt_pk_bf16_f32 v99, v98, v99
    v_lshlrev_b32 v234, 16, v97
    v_and_b32 v238, 0xffff0000, v97
    v_lshlrev_b32 v242, 16, v99
    v_and_b32 v246, 0xffff0000, v99
    v_lshlrev_b32 v100, 16, v206
    v_and_b32 v101, 0xffff0000, v206
    v_lshlrev_b32 v102, 16, v207
    v_and_b32 v103, 0xffff0000, v207
    v_pk_mul_f32 v[100:101], v[100:101], v[88:89]
    v_pk_mul_f32 v[102:103], v[102:103], v[90:91]
    v_cvt_pk_bf16_f32 v101, v100, v101
    v_cvt_pk_bf16_f32 v103, v102, v103
    v_lshlrev_b32 v235, 16, v101
    v_and_b32 v239, 0xffff0000, v101
    v_lshlrev_b32 v243, 16, v103
    v_and_b32 v247, 0xffff0000, v103
    s_waitcnt lgkmcnt(0)
    v_pk_mul_f32 v[168:169], v[80:81], v[176:177] op_sel:[0,0] op_sel_hi:[1,0]
    v_pk_fma_f32 v[168:169], v[80:81], v[176:177], v[168:169] op_sel:[1,1,0] op_sel_hi:[0,1,1] neg_lo:[1,0,0]
    v_pk_mul_f32 v[170:171], v[82:83], v[178:179] op_sel:[0,0] op_sel_hi:[1,0]
    v_pk_fma_f32 v[170:171], v[82:83], v[178:179], v[170:171] op_sel:[1,1,0] op_sel_hi:[0,1,1] neg_lo:[1,0,0]
    v_pk_mul_f32 v[172:173], v[84:85], v[180:181] op_sel:[0,0] op_sel_hi:[1,0]
    v_pk_fma_f32 v[172:173], v[84:85], v[180:181], v[172:173] op_sel:[1,1,0] op_sel_hi:[0,1,1] neg_lo:[1,0,0]
    v_pk_mul_f32 v[174:175], v[86:87], v[182:183] op_sel:[0,0] op_sel_hi:[1,0]
    v_pk_fma_f32 v[174:175], v[86:87], v[182:183], v[174:175] op_sel:[1,1,0] op_sel_hi:[0,1,1] neg_lo:[1,0,0]
L_wait1:
    ds_read_b32 v209, v6
    ds_read_b128 v[176:179], v7
    ds_read_b128 v[180:183], v7 offset:16
    s_waitcnt lgkmcnt(0)
    v_cmp_eq_u32 vcc, 0, v209
    s_cbranch_vccnz L_wait1
    v_pk_fma_f32 v[72:73], v[168:169], v[176:177], v[72:73] op_sel:[0,0,0] op_sel_hi:[1,0,1]
    v_pk_fma_f32 v[72:73], v[168:169], v[176:177], v[72:73] op_sel:[1,1,0] op_sel_hi:[0,1,1] neg_lo:[1,0,0]
    v_pk_fma_f32 v[74:75], v[170:171], v[178:179], v[74:75] op_sel:[0,0,0] op_sel_hi:[1,0,1]
    v_pk_fma_f32 v[74:75], v[170:171], v[178:179], v[74:75] op_sel:[1,1,0] op_sel_hi:[0,1,1] neg_lo:[1,0,0]
    v_pk_fma_f32 v[76:77], v[172:173], v[180:181], v[76:77] op_sel:[0,0,0] op_sel_hi:[1,0,1]
    v_pk_fma_f32 v[76:77], v[172:173], v[180:181], v[76:77] op_sel:[1,1,0] op_sel_hi:[0,1,1] neg_lo:[1,0,0]
    v_pk_fma_f32 v[78:79], v[174:175], v[182:183], v[78:79] op_sel:[0,0,0] op_sel_hi:[1,0,1]
    v_pk_fma_f32 v[78:79], v[174:175], v[182:183], v[78:79] op_sel:[1,1,0] op_sel_hi:[0,1,1] neg_lo:[1,0,0]
    v_pk_fma_f32 v[8:9], v[72:73], v[104:105], v[8:9] op_sel:[0,0,0] op_sel_hi:[0,1,1]
    v_pk_fma_f32 v[8:9], v[72:73], v[106:107], v[8:9] op_sel:[1,0,0] op_sel_hi:[1,1,1] neg_lo:[1,0,0] neg_hi:[1,0,0]
    v_pk_fma_f32 v[12:13], v[74:75], v[108:109], v[12:13] op_sel:[0,0,0] op_sel_hi:[0,1,1]
    v_pk_fma_f32 v[12:13], v[74:75], v[110:111], v[12:13] op_sel:[1,0,0] op_sel_hi:[1,1,1] neg_lo:[1,0,0] neg_hi:[1,0,0]
    v_pk_fma_f32 v[16:17], v[76:77], v[112:113], v[16:17] op_sel:[0,0,0] op_sel_hi:[0,1,1]
    v_pk_fma_f32 v[16:17], v[76:77], v[114:115], v[16:17] op_sel:[1,0,0] op_sel_hi:[1,1,1] neg_lo:[1,0,0] neg_hi:[1,0,0]
    v_pk_fma_f32 v[20:21], v[78:79], v[116:117], v[20:21] op_sel:[0,0,0] op_sel_hi:[0,1,1]
    v_pk_fma_f32 v[20:21], v[78:79], v[118:119], v[20:21] op_sel:[1,0,0] op_sel_hi:[1,1,1] neg_lo:[1,0,0] neg_hi:[1,0,0]
    v_cvt_pk_bf16_f32 v192, v8, v12
    v_cvt_pk_bf16_f32 v193, v16, v20
    v_cvt_pk_bf16_f32 v80, v9, v13
    v_cvt_pk_bf16_f32 v81, v17, v21
    ds_write_b64 v210, v[192:193]
    v_pk_fma_f32 v[10:11], v[72:73], v[120:121], v[10:11] op_sel:[0,0,0] op_sel_hi:[0,1,1]
    v_pk_fma_f32 v[10:11], v[72:73], v[122:123], v[10:11] op_sel:[1,0,0] op_sel_hi:[1,1,1] neg_lo:[1,0,0] neg_hi:[1,0,0]
    v_pk_fma_f32 v[14:15], v[74:75], v[124:125], v[14:15] op_sel:[0,0,0] op_sel_hi:[0,1,1]
    v_pk_fma_f32 v[14:15], v[74:75], v[126:127], v[14:15] op_sel:[1,0,0] op_sel_hi:[1,1,1] neg_lo:[1,0,0] neg_hi:[1,0,0]
    v_pk_fma_f32 v[18:19], v[76:77], v[128:129], v[18:19] op_sel:[0,0,0] op_sel_hi:[0,1,1]
    v_pk_fma_f32 v[18:19], v[76:77], v[130:131], v[18:19] op_sel:[1,0,0] op_sel_hi:[1,1,1] neg_lo:[1,0,0] neg_hi:[1,0,0]
    v_pk_fma_f32 v[22:23], v[78:79], v[132:133], v[22:23] op_sel:[0,0,0] op_sel_hi:[0,1,1]
    v_pk_fma_f32 v[22:23], v[78:79], v[134:135], v[22:23] op_sel:[1,0,0] op_sel_hi:[1,1,1] neg_lo:[1,0,0] neg_hi:[1,0,0]
    v_cvt_pk_bf16_f32 v196, v10, v14
    v_cvt_pk_bf16_f32 v197, v18, v22
    v_cvt_pk_bf16_f32 v84, v11, v15
    v_cvt_pk_bf16_f32 v85, v19, v23
    ds_write_b64 v211, v[196:197]
    v_pk_fma_f32 v[40:41], v[72:73], v[136:137], v[40:41] op_sel:[0,0,0] op_sel_hi:[0,1,1]
    v_pk_fma_f32 v[40:41], v[72:73], v[138:139], v[40:41] op_sel:[1,0,0] op_sel_hi:[1,1,1] neg_lo:[1,0,0] neg_hi:[1,0,0]
    v_pk_fma_f32 v[44:45], v[74:75], v[140:141], v[44:45] op_sel:[0,0,0] op_sel_hi:[0,1,1]
    v_pk_fma_f32 v[44:45], v[74:75], v[142:143], v[44:45] op_sel:[1,0,0] op_sel_hi:[1,1,1] neg_lo:[1,0,0] neg_hi:[1,0,0]
    v_pk_fma_f32 v[48:49], v[76:77], v[144:145], v[48:49] op_sel:[0,0,0] op_sel_hi:[0,1,1]
    v_pk_fma_f32 v[48:49], v[76:77], v[146:147], v[48:49] op_sel:[1,0,0] op_sel_hi:[1,1,1] neg_lo:[1,0,0] neg_hi:[1,0,0]
    v_pk_fma_f32 v[52:53], v[78:79], v[148:149], v[52:53] op_sel:[0,0,0] op_sel_hi:[0,1,1]
    v_pk_fma_f32 v[52:53], v[78:79], v[150:151], v[52:53] op_sel:[1,0,0] op_sel_hi:[1,1,1] neg_lo:[1,0,0] neg_hi:[1,0,0]
    v_cvt_pk_bf16_f32 v200, v40, v44
    v_cvt_pk_bf16_f32 v201, v48, v52
    v_cvt_pk_bf16_f32 v88, v41, v45
    v_cvt_pk_bf16_f32 v89, v49, v53
    ds_write_b64 v212, v[200:201]
    v_pk_fma_f32 v[42:43], v[72:73], v[152:153], v[42:43] op_sel:[0,0,0] op_sel_hi:[0,1,1]
    v_pk_fma_f32 v[42:43], v[72:73], v[154:155], v[42:43] op_sel:[1,0,0] op_sel_hi:[1,1,1] neg_lo:[1,0,0] neg_hi:[1,0,0]
    v_pk_fma_f32 v[46:47], v[74:75], v[156:157], v[46:47] op_sel:[0,0,0] op_sel_hi:[0,1,1]
    v_pk_fma_f32 v[46:47], v[74:75], v[158:159], v[46:47] op_sel:[1,0,0] op_sel_hi:[1,1,1] neg_lo:[1,0,0] neg_hi:[1,0,0]
    v_pk_fma_f32 v[50:51], v[76:77], v[160:161], v[50:51] op_sel:[0,0,0] op_sel_hi:[0,1,1]
    v_pk_fma_f32 v[50:51], v[76:77], v[162:163], v[50:51] op_sel:[1,0,0] op_sel_hi:[1,1,1] neg_lo:[1,0,0] neg_hi:[1,0,0]
    v_pk_fma_f32 v[54:55], v[78:79], v[164:165], v[54:55] op_sel:[0,0,0] op_sel_hi:[0,1,1]
    v_pk_fma_f32 v[54:55], v[78:79], v[166:167], v[54:55] op_sel:[1,0,0] op_sel_hi:[1,1,1] neg_lo:[1,0,0] neg_hi:[1,0,0]
    v_cvt_pk_bf16_f32 v204, v42, v46
    v_cvt_pk_bf16_f32 v205, v50, v54
    v_cvt_pk_bf16_f32 v92, v43, v47
    v_cvt_pk_bf16_f32 v93, v51, v55
    ds_write_b64 v213, v[204:205]
    ds_read_b128 v[8:11], v214 offset:0
    ds_read_b128 v[12:15], v215 offset:1024
    ds_write_b64 v210, v[80:81]
    ds_write_b64 v211, v[84:85]
    ds_write_b64 v212, v[88:89]
    ds_write_b64 v213, v[92:93]
    ds_read_b128 v[40:43], v214 offset:0
    ds_read_b128 v[44:47], v215 offset:1024
    v_pk_fma_f32 v[24:25], v[72:73], v[104:105], v[24:25] op_sel:[1,0,0] op_sel_hi:[1,1,1]
    v_pk_fma_f32 v[24:25], v[72:73], v[106:107], v[24:25] op_sel:[0,0,0] op_sel_hi:[0,1,1]
    v_pk_fma_f32 v[28:29], v[74:75], v[108:109], v[28:29] op_sel:[1,0,0] op_sel_hi:[1,1,1]
    v_pk_fma_f32 v[28:29], v[74:75], v[110:111], v[28:29] op_sel:[0,0,0] op_sel_hi:[0,1,1]
    v_pk_fma_f32 v[32:33], v[76:77], v[112:113], v[32:33] op_sel:[1,0,0] op_sel_hi:[1,1,1]
    v_pk_fma_f32 v[32:33], v[76:77], v[114:115], v[32:33] op_sel:[0,0,0] op_sel_hi:[0,1,1]
    v_pk_fma_f32 v[36:37], v[78:79], v[116:117], v[36:37] op_sel:[1,0,0] op_sel_hi:[1,1,1]
    v_pk_fma_f32 v[36:37], v[78:79], v[118:119], v[36:37] op_sel:[0,0,0] op_sel_hi:[0,1,1]
    v_cvt_pk_bf16_f32 v194, -v24, -v28
    v_cvt_pk_bf16_f32 v195, -v32, -v36
    v_cvt_pk_bf16_f32 v82, -v25, -v29
    v_cvt_pk_bf16_f32 v83, -v33, -v37
    ds_write_b64 v210, v[194:195]
    v_pk_fma_f32 v[26:27], v[72:73], v[120:121], v[26:27] op_sel:[1,0,0] op_sel_hi:[1,1,1]
    v_pk_fma_f32 v[26:27], v[72:73], v[122:123], v[26:27] op_sel:[0,0,0] op_sel_hi:[0,1,1]
    v_pk_fma_f32 v[30:31], v[74:75], v[124:125], v[30:31] op_sel:[1,0,0] op_sel_hi:[1,1,1]
    v_pk_fma_f32 v[30:31], v[74:75], v[126:127], v[30:31] op_sel:[0,0,0] op_sel_hi:[0,1,1]
    v_pk_fma_f32 v[34:35], v[76:77], v[128:129], v[34:35] op_sel:[1,0,0] op_sel_hi:[1,1,1]
    v_pk_fma_f32 v[34:35], v[76:77], v[130:131], v[34:35] op_sel:[0,0,0] op_sel_hi:[0,1,1]
    v_pk_fma_f32 v[38:39], v[78:79], v[132:133], v[38:39] op_sel:[1,0,0] op_sel_hi:[1,1,1]
    v_pk_fma_f32 v[38:39], v[78:79], v[134:135], v[38:39] op_sel:[0,0,0] op_sel_hi:[0,1,1]
    v_cvt_pk_bf16_f32 v198, -v26, -v30
    v_cvt_pk_bf16_f32 v199, -v34, -v38
    v_cvt_pk_bf16_f32 v86, -v27, -v31
    v_cvt_pk_bf16_f32 v87, -v35, -v39
    ds_write_b64 v211, v[198:199]
    s_waitcnt lgkmcnt(2)
    buffer_store_dwordx4 v[8:11], v1, s[60:63], s14 offen offset:0 sc1
    buffer_store_dwordx4 v[12:15], v1, s[60:63], s14 offen offset:1024 sc1
    buffer_store_dwordx4 v[40:43], v1, s[60:63], s15 offen offset:0 sc1
    buffer_store_dwordx4 v[44:47], v1, s[60:63], s15 offen offset:1024 sc1
    v_pk_fma_f32 v[56:57], v[72:73], v[136:137], v[56:57] op_sel:[1,0,0] op_sel_hi:[1,1,1]
    v_pk_fma_f32 v[56:57], v[72:73], v[138:139], v[56:57] op_sel:[0,0,0] op_sel_hi:[0,1,1]
    v_pk_fma_f32 v[60:61], v[74:75], v[140:141], v[60:61] op_sel:[1,0,0] op_sel_hi:[1,1,1]
    v_pk_fma_f32 v[60:61], v[74:75], v[142:143], v[60:61] op_sel:[0,0,0] op_sel_hi:[0,1,1]
    v_pk_fma_f32 v[64:65], v[76:77], v[144:145], v[64:65] op_sel:[1,0,0] op_sel_hi:[1,1,1]
    v_pk_fma_f32 v[64:65], v[76:77], v[146:147], v[64:65] op_sel:[0,0,0] op_sel_hi:[0,1,1]
    v_pk_fma_f32 v[68:69], v[78:79], v[148:149], v[68:69] op_sel:[1,0,0] op_sel_hi:[1,1,1]
    v_pk_fma_f32 v[68:69], v[78:79], v[150:151], v[68:69] op_sel:[0,0,0] op_sel_hi:[0,1,1]
    v_cvt_pk_bf16_f32 v202, -v56, -v60
    v_cvt_pk_bf16_f32 v203, -v64, -v68
    v_cvt_pk_bf16_f32 v90, -v57, -v61
    v_cvt_pk_bf16_f32 v91, -v65, -v69
    ds_write_b64 v212, v[202:203]
    v_pk_fma_f32 v[58:59], v[72:73], v[152:153], v[58:59] op_sel:[1,0,0] op_sel_hi:[1,1,1]
    v_pk_fma_f32 v[58:59], v[72:73], v[154:155], v[58:59] op_sel:[0,0,0] op_sel_hi:[0,1,1]
    v_pk_fma_f32 v[62:63], v[74:75], v[156:157], v[62:63] op_sel:[1,0,0] op_sel_hi:[1,1,1]
    v_pk_fma_f32 v[62:63], v[74:75], v[158:159], v[62:63] op_sel:[0,0,0] op_sel_hi:[0,1,1]
    v_pk_fma_f32 v[66:67], v[76:77], v[160:161], v[66:67] op_sel:[1,0,0] op_sel_hi:[1,1,1]
    v_pk_fma_f32 v[66:67], v[76:77], v[162:163], v[66:67] op_sel:[0,0,0] op_sel_hi:[0,1,1]
    v_pk_fma_f32 v[70:71], v[78:79], v[164:165], v[70:71] op_sel:[1,0,0] op_sel_hi:[1,1,1]
    v_pk_fma_f32 v[70:71], v[78:79], v[166:167], v[70:71] op_sel:[0,0,0] op_sel_hi:[0,1,1]
    v_cvt_pk_bf16_f32 v206, -v58, -v62
    v_cvt_pk_bf16_f32 v207, -v66, -v70
    v_cvt_pk_bf16_f32 v94, -v59, -v63
    v_cvt_pk_bf16_f32 v95, -v67, -v71
    ds_write_b64 v213, v[206:207]
    ds_read_b128 v[24:27], v214 offset:0
    ds_read_b128 v[28:31], v215 offset:1024
    ds_write_b64 v210, v[82:83]
    ds_write_b64 v211, v[86:87]
    ds_write_b64 v212, v[90:91]
    ds_write_b64 v213, v[94:95]
    ds_read_b128 v[56:59], v214 offset:0
    ds_read_b128 v[60:63], v215 offset:1024
    s_waitcnt lgkmcnt(0)
    buffer_store_dwordx4 v[24:27], v1, s[60:63], s14 offen offset:2048 sc1
    buffer_store_dwordx4 v[28:31], v1, s[60:63], s14 offen offset:3072 sc1
    buffer_store_dwordx4 v[56:59], v1, s[60:63], s15 offen offset:2048 sc1
    buffer_store_dwordx4 v[60:63], v1, s[60:63], s15 offen offset:3072 sc1
L_wait3:
    ds_read_b32 v7, v6 offset:16
    s_waitcnt lgkmcnt(0)
    v_cmp_ne_u32 vcc, 2, v7
    s_cbranch_vccnz L_wait3
    ds_read_b128 v[104:107], v250 offset:0
    ds_read_b128 v[108:111], v250 offset:2048
    ds_read_b128 v[112:115], v250 offset:4096
    ds_read_b128 v[116:119], v250 offset:6144
    ds_read_b128 v[120:123], v251 offset:0
    ds_read_b128 v[124:127], v251 offset:2048
    ds_read_b128 v[128:131], v251 offset:4096
    ds_read_b128 v[132:135], v251 offset:6144
    v_mov_b32 v208, 1
    v_mov_b32 v210, 0
    s_lshl_b32 s8, s4, 11
    s_lshl_b32 s9, s5, 7
    s_add_u32 s8, s8, s9
    s_add_u32 s8, s8, 0x540000
    ds_read_b128 v[136:139], v250 offset:8192
    ds_read_b128 v[140:143], v250 offset:10240
    ds_read_b128 v[144:147], v250 offset:12288
    ds_read_b128 v[148:151], v250 offset:14336
    ds_read_b128 v[152:155], v251 offset:8192
    ds_read_b128 v[156:159], v251 offset:10240
    ds_read_b128 v[160:163], v251 offset:12288
    ds_read_b128 v[164:167], v251 offset:14336
    s_waitcnt lgkmcnt(15)
    v_mfma_f32_16x16x32_bf16 v[216:219], v[8:11], v[104:107], v[216:219]
    v_mfma_f32_16x16x32_bf16 v[232:235], v[40:43], v[104:107], v[232:235]
    s_waitcnt lgkmcnt(14)
    v_mfma_f32_16x16x32_bf16 v[220:223], v[8:11], v[108:111], v[220:223]
    v_mfma_f32_16x16x32_bf16 v[236:239], v[40:43], v[108:111], v[236:239]
    s_waitcnt lgkmcnt(13)
    v_mfma_f32_16x16x32_bf16 v[224:227], v[8:11], v[112:115], v[224:227]
    v_mfma_f32_16x16x32_bf16 v[240:243], v[40:43], v[112:115], v[240:243]
    s_waitcnt lgkmcnt(12)
    v_mfma_f32_16x16x32_bf16 v[228:231], v[8:11], v[116:119], v[228:231]
    v_mfma_f32_16x16x32_bf16 v[244:247], v[40:43], v[116:119], v[244:247]
    s_waitcnt lgkmcnt(11)
    v_mfma_f32_16x16x32_bf16 v[216:219], v[12:15], v[120:123], v[216:219]
    v_mfma_f32_16x16x32_bf16 v[232:235], v[44:47], v[120:123], v[232:235]
    s_waitcnt lgkmcnt(10)
    v_mfma_f32_16x16x32_bf16 v[220:223], v[12:15], v[124:127], v[220:223]
    v_mfma_f32_16x16x32_bf16 v[236:239], v[44:47], v[124:127], v[236:239]
    s_waitcnt lgkmcnt(9)
    v_mfma_f32_16x16x32_bf16 v[224:227], v[12:15], v[128:131], v[224:227]
    v_mfma_f32_16x16x32_bf16 v[240:243], v[44:47], v[128:131], v[240:243]
    s_waitcnt lgkmcnt(8)
    v_mfma_f32_16x16x32_bf16 v[228:231], v[12:15], v[132:135], v[228:231]
    v_mfma_f32_16x16x32_bf16 v[244:247], v[44:47], v[132:135], v[244:247]
    s_waitcnt lgkmcnt(7)
    v_mfma_f32_16x16x32_bf16 v[216:219], v[24:27], v[136:139], v[216:219]
    v_mfma_f32_16x16x32_bf16 v[232:235], v[56:59], v[136:139], v[232:235]
    s_waitcnt lgkmcnt(6)
    v_mfma_f32_16x16x32_bf16 v[220:223], v[24:27], v[140:143], v[220:223]
    v_mfma_f32_16x16x32_bf16 v[236:239], v[56:59], v[140:143], v[236:239]
    s_waitcnt lgkmcnt(5)
    v_mfma_f32_16x16x32_bf16 v[224:227], v[24:27], v[144:147], v[224:227]
    v_mfma_f32_16x16x32_bf16 v[240:243], v[56:59], v[144:147], v[240:243]
    s_waitcnt lgkmcnt(4)
    v_mfma_f32_16x16x32_bf16 v[228:231], v[24:27], v[148:151], v[228:231]
    v_mfma_f32_16x16x32_bf16 v[244:247], v[56:59], v[148:151], v[244:247]
    s_waitcnt lgkmcnt(3)
    v_mfma_f32_16x16x32_bf16 v[216:219], v[28:31], v[152:155], v[216:219]
    v_mfma_f32_16x16x32_bf16 v[232:235], v[60:63], v[152:155], v[232:235]
    s_waitcnt lgkmcnt(2)
    v_mfma_f32_16x16x32_bf16 v[220:223], v[28:31], v[156:159], v[220:223]
    v_mfma_f32_16x16x32_bf16 v[236:239], v[60:63], v[156:159], v[236:239]
    s_waitcnt lgkmcnt(1)
    v_mfma_f32_16x16x32_bf16 v[224:227], v[28:31], v[160:163], v[224:227]
    v_mfma_f32_16x16x32_bf16 v[240:243], v[60:63], v[160:163], v[240:243]
    s_waitcnt lgkmcnt(0)
    v_mfma_f32_16x16x32_bf16 v[228:231], v[28:31], v[164:167], v[228:231]
    v_mfma_f32_16x16x32_bf16 v[244:247], v[60:63], v[164:167], v[244:247]
    s_waitcnt vmcnt(0)
    s_mov_b64 exec, 1
    ds_add_rtn_u32 v208, v6, v208 offset:4
    s_waitcnt lgkmcnt(0)
    v_cmp_ne_u32 vcc, 3, v208
    s_cbranch_vccnz L_notlast
    buffer_store_dword v209, v210, s[60:63], s8 offen sc1
L_notlast:
    s_mov_b64 exec, -1
L_B_g2:
    v_xor_b32 v249, 64, v248
    v_add_u32 v250, 0x10000, v248
    v_add_u32 v251, 0x10000, v249
    s_add_u32 s14, s14, 4096
    s_cmp_eq_u32 s14, s13
    s_cselect_b32 s14, s12, s14
    s_and_b32 s6, s3, 3
    s_lshl_b32 s8, s6, 12
    s_add_u32 s8, s8, 131072
    v_lshl_add_u32 v2, v0, 4, s8
    s_lshl_b32 s6, s6, 2
    s_add_u32 s6, s6, 159264
    v_mov_b32 v6, s6
    s_lshl_b32 s8, s5, 8
    s_add_u32 s8, s8, 2304
    s_barrier
    buffer_load_dwordx4 v[72:75], v1, s[60:63], s14 offen offset:0 sc1
    buffer_load_dwordx4 v[76:79], v1, s[60:63], s14 offen offset:1024 sc1
    buffer_load_dwordx4 v[80:83], v1, s[60:63], s14 offen offset:2048 sc1
    buffer_load_dwordx4 v[84:87], v1, s[60:63], s14 offen offset:3072 sc1
    s_add_u32 s14, s14, 4096
    s_cmp_eq_u32 s14, s13
    s_cselect_b32 s14, s12, s14
    s_cmp_ge_u32 s3, 4
    s_cbranch_scc1 L_m1
    ds_write_b128 v2, v[232:235] offset:0
    ds_write_b128 v2, v[236:239] offset:1024
    ds_write_b128 v2, v[240:243] offset:2048
    ds_write_b128 v2, v[244:247] offset:3072
    ds_write_b32 v6, v6
    v_mov_b32 v40, 0
    v_mov_b32 v41, 0
    v_mov_b32 v42, 0
    v_mov_b32 v43, 0
    v_mov_b32 v44, 0
    v_mov_b32 v45, 0
    v_mov_b32 v46, 0
    v_mov_b32 v47, 0
    v_mov_b32 v48, 0
    v_mov_b32 v49, 0
    v_mov_b32 v50, 0
    v_mov_b32 v51, 0
    v_mov_b32 v52, 0
    v_mov_b32 v53, 0
    v_mov_b32 v54, 0
    v_mov_b32 v55, 0
L_m1:
    ds_read_b128 v[8:11], v248 offset:32768
    ds_read_b128 v[12:15], v248 offset:34816
    ds_read_b128 v[16:19], v248 offset:36864
    ds_read_b128 v[20:23], v248 offset:38912
    s_waitcnt vmcnt(3)
    ds_read_b128 v[24:27], v249 offset:32768
    s_waitcnt lgkmcnt(4)
    v_mfma_f32_16x16x32_bf16 v[216:219], v[72:75], v[8:11], v[216:219]
    ds_read_b128 v[28:31], v249 offset:34816
    s_waitcnt lgkmcnt(4)
    v_mfma_f32_16x16x32_bf16 v[220:223], v[72:75], v[12:15], v[220:223]
    buffer_load_dwordx4 v[88:91], v1, s[60:63], s14 offen offset:0 sc1
    ds_read_b128 v[32:35], v249 offset:36864
    s_waitcnt lgkmcnt(4)
    v_mfma_f32_16x16x32_bf16 v[224:227], v[72:75], v[16:19], v[224:227]
    ds_read_b128 v[36:39], v249 offset:38912
    s_waitcnt lgkmcnt(4)
    v_mfma_f32_16x16x32_bf16 v[228:231], v[72:75], v[20:23], v[228:231]
    buffer_load_dwordx4 v[92:95], v1, s[60:63], s14 offen offset:1024 sc1
    s_waitcnt vmcnt(4)
    ds_read_b128 v[8:11], v248 offset:40960
    s_waitcnt lgkmcnt(4)
    v_mfma_f32_16x16x32_bf16 v[216:219], v[76:79], v[24:27], v[216:219]
    ds_read_b128 v[12:15], v248 offset:43008
    s_waitcnt lgkmcnt(4)
    v_mfma_f32_16x16x32_bf16 v[220:223], v[76:79], v[28:31], v[220:223]
    buffer_load_dwordx4 v[96:99], v1, s[60:63], s14 offen offset:2048 sc1
    ds_read_b128 v[16:19], v248 offset:45056
    s_waitcnt lgkmcnt(4)
    v_mfma_f32_16x16x32_bf16 v[224:227], v[76:79], v[32:35], v[224:227]
    ds_read_b128 v[20:23], v248 offset:47104
    s_waitcnt lgkmcnt(4)
    v_mfma_f32_16x16x32_bf16 v[228:231], v[76:79], v[36:39], v[228:231]
    buffer_load_dwordx4 v[100:103], v1, s[60:63], s14 offen offset:3072 sc1
    s_add_u32 s14, s14, 4096
    s_cmp_eq_u32 s14, s13
    s_cselect_b32 s14, s12, s14
    s_waitcnt vmcnt(5)
    ds_read_b128 v[24:27], v249 offset:40960
    s_waitcnt lgkmcnt(4)
    v_mfma_f32_16x16x32_bf16 v[216:219], v[80:83], v[8:11], v[216:219]
    ds_read_b128 v[28:31], v249 offset:43008
    s_waitcnt lgkmcnt(4)
    v_mfma_f32_16x16x32_bf16 v[220:223], v[80:83], v[12:15], v[220:223]
    ds_read_b128 v[32:35], v249 offset:45056
    s_waitcnt lgkmcnt(4)
    v_mfma_f32_16x16x32_bf16 v[224:227], v[80:83], v[16:19], v[224:227]
    ds_read_b128 v[36:39], v249 offset:47104
    s_waitcnt lgkmcnt(4)
    v_mfma_f32_16x16x32_bf16 v[228:231], v[80:83], v[20:23], v[228:231]
    buffer_load_dwordx4 v[104:107], v1, s[60:63], s14 offen offset:0 sc1
    s_waitcnt vmcnt(5)
    ds_read_b128 v[8:11], v248 offset:49152
    s_waitcnt lgkmcnt(4)
    v_mfma_f32_16x16x32_bf16 v[216:219], v[84:87], v[24:27], v[216:219]
    ds_read_b128 v[12:15], v248 offset:51200
    s_waitcnt lgkmcnt(4)
    v_mfma_f32_16x16x32_bf16 v[220:223], v[84:87], v[28:31], v[220:223]
    ds_read_b128 v[16:19], v248 offset:53248
    s_waitcnt lgkmcnt(4)
    v_mfma_f32_16x16x32_bf16 v[224:227], v[84:87], v[32:35], v[224:227]
    ds_read_b128 v[20:23], v248 offset:55296
    s_waitcnt lgkmcnt(4)
    v_mfma_f32_16x16x32_bf16 v[228:231], v[84:87], v[36:39], v[228:231]
    buffer_load_dwordx4 v[108:111], v1, s[60:63], s14 offen offset:1024 sc1
    s_waitcnt vmcnt(5)
    ds_read_b128 v[24:27], v249 offset:49152
    s_waitcnt lgkmcnt(4)
    v_mfma_f32_16x16x32_bf16 v[216:219], v[88:91], v[8:11], v[216:219]
    ds_read_b128 v[28:31], v249 offset:51200
    s_waitcnt lgkmcnt(4)
    v_mfma_f32_16x16x32_bf16 v[220:223], v[88:91], v[12:15], v[220:223]
    ds_read_b128 v[32:35], v249 offset:53248
    s_waitcnt lgkmcnt(4)
    v_mfma_f32_16x16x32_bf16 v[224:227], v[88:91], v[16:19], v[224:227]
    ds_read_b128 v[36:39], v249 offset:55296
    s_waitcnt lgkmcnt(4)
    v_mfma_f32_16x16x32_bf16 v[228:231], v[88:91], v[20:23], v[228:231]
    buffer_load_dwordx4 v[112:115], v1, s[60:63], s14 offen offset:2048 sc1
    s_waitcnt vmcnt(5)
    ds_read_b128 v[8:11], v248 offset:57344
    s_waitcnt lgkmcnt(4)
    v_mfma_f32_16x16x32_bf16 v[216:219], v[92:95], v[24:27], v[216:219]
    ds_read_b128 v[12:15], v248 offset:59392
    s_waitcnt lgkmcnt(4)
    v_mfma_f32_16x16x32_bf16 v[220:223], v[92:95], v[28:31], v[220:223]
    ds_read_b128 v[16:19], v248 offset:61440
    s_waitcnt lgkmcnt(4)
    v_mfma_f32_16x16x32_bf16 v[224:227], v[92:95], v[32:35], v[224:227]
    ds_read_b128 v[20:23], v248 offset:63488
    s_waitcnt lgkmcnt(4)
    v_mfma_f32_16x16x32_bf16 v[228:231], v[92:95], v[36:39], v[228:231]
    buffer_load_dwordx4 v[116:119], v1, s[60:63], s14 offen offset:3072 sc1
    s_add_u32 s14, s14, 4096
    s_cmp_eq_u32 s14, s13
    s_cselect_b32 s14, s12, s14
    s_waitcnt vmcnt(5)
    ds_read_b128 v[24:27], v249 offset:57344
    s_waitcnt lgkmcnt(4)
    v_mfma_f32_16x16x32_bf16 v[216:219], v[96:99], v[8:11], v[216:219]
    ds_read_b128 v[28:31], v249 offset:59392
    s_waitcnt lgkmcnt(4)
    v_mfma_f32_16x16x32_bf16 v[220:223], v[96:99], v[12:15], v[220:223]
    ds_read_b128 v[32:35], v249 offset:61440
    s_waitcnt lgkmcnt(4)
    v_mfma_f32_16x16x32_bf16 v[224:227], v[96:99], v[16:19], v[224:227]
    ds_read_b128 v[36:39], v249 offset:63488
    s_waitcnt lgkmcnt(4)
    v_mfma_f32_16x16x32_bf16 v[228:231], v[96:99], v[20:23], v[228:231]
    buffer_load_dwordx4 v[120:123], v1, s[60:63], s14 offen offset:0 sc1
    s_waitcnt vmcnt(5)
    ds_read_b128 v[8:11], v250 offset:0
    s_waitcnt lgkmcnt(4)
    v_mfma_f32_16x16x32_bf16 v[216:219], v[100:103], v[24:27], v[216:219]
    ds_read_b128 v[12:15], v250 offset:2048
    s_waitcnt lgkmcnt(4)
    v_mfma_f32_16x16x32_bf16 v[220:223], v[100:103], v[28:31], v[220:223]
    ds_read_b128 v[16:19], v250 offset:4096
    s_waitcnt lgkmcnt(4)
    v_mfma_f32_16x16x32_bf16 v[224:227], v[100:103], v[32:35], v[224:227]
    ds_read_b128 v[20:23], v250 offset:6144
    s_waitcnt lgkmcnt(4)
    v_mfma_f32_16x16x32_bf16 v[228:231], v[100:103], v[36:39], v[228:231]
    buffer_load_dwordx4 v[124:127], v1, s[60:63], s14 offen offset:1024 sc1
    s_waitcnt vmcnt(5)
    ds_read_b128 v[24:27], v251 offset:0
    s_waitcnt lgkmcnt(4)
    v_mfma_f32_16x16x32_bf16 v[216:219], v[104:107], v[8:11], v[216:219]
    ds_read_b128 v[28:31], v251 offset:2048
    s_waitcnt lgkmcnt(4)
    v_mfma_f32_16x16x32_bf16 v[220:223], v[104:107], v[12:15], v[220:223]
    ds_read_b128 v[32:35], v251 offset:4096
    s_waitcnt lgkmcnt(4)
    v_mfma_f32_16x16x32_bf16 v[224:227], v[104:107], v[16:19], v[224:227]
    ds_read_b128 v[36:39], v251 offset:6144
    s_waitcnt lgkmcnt(4)
    v_mfma_f32_16x16x32_bf16 v[228:231], v[104:107], v[20:23], v[228:231]
    buffer_load_dwordx4 v[128:131], v1, s[60:63], s14 offen offset:2048 sc1
    s_waitcnt vmcnt(5)
    ds_read_b128 v[8:11], v250 offset:8192
    s_waitcnt lgkmcnt(4)
    v_mfma_f32_16x16x32_bf16 v[216:219], v[108:111], v[24:27], v[216:219]
    ds_read_b128 v[12:15], v250 offset:10240
    s_waitcnt lgkmcnt(4)
    v_mfma_f32_16x16x32_bf16 v[220:223], v[108:111], v[28:31], v[220:223]
    ds_read_b128 v[16:19], v250 offset:12288
    s_waitcnt lgkmcnt(4)
    v_mfma_f32_16x16x32_bf16 v[224:227], v[108:111], v[32:35], v[224:227]
    ds_read_b128 v[20:23], v250 offset:14336
    s_waitcnt lgkmcnt(4)
    v_mfma_f32_16x16x32_bf16 v[228:231], v[108:111], v[36:39], v[228:231]
    buffer_load_dwordx4 v[132:135], v1, s[60:63], s14 offen offset:3072 sc1
    s_add_u32 s14, s14, 4096
    s_cmp_eq_u32 s14, s13
    s_cselect_b32 s14, s12, s14
    s_waitcnt vmcnt(5)
    ds_read_b128 v[24:27], v251 offset:8192
    s_waitcnt lgkmcnt(4)
    v_mfma_f32_16x16x32_bf16 v[216:219], v[112:115], v[8:11], v[216:219]
    ds_read_b128 v[28:31], v251 offset:10240
    s_waitcnt lgkmcnt(4)
    v_mfma_f32_16x16x32_bf16 v[220:223], v[112:115], v[12:15], v[220:223]
    ds_read_b128 v[32:35], v251 offset:12288
    s_waitcnt lgkmcnt(4)
    v_mfma_f32_16x16x32_bf16 v[224:227], v[112:115], v[16:19], v[224:227]
    ds_read_b128 v[36:39], v251 offset:14336
    s_waitcnt lgkmcnt(4)
    v_mfma_f32_16x16x32_bf16 v[228:231], v[112:115], v[20:23], v[228:231]
    buffer_load_dwordx4 v[136:139], v1, s[60:63], s14 offen offset:0 sc1
    s_waitcnt vmcnt(5)
    ds_read_b128 v[8:11], v250 offset:16384
    s_waitcnt lgkmcnt(4)
    v_mfma_f32_16x16x32_bf16 v[216:219], v[116:119], v[24:27], v[216:219]
    ds_read_b128 v[12:15], v250 offset:18432
    s_waitcnt lgkmcnt(4)
    v_mfma_f32_16x16x32_bf16 v[220:223], v[116:119], v[28:31], v[220:223]
    ds_read_b128 v[16:19], v250 offset:20480
    s_waitcnt lgkmcnt(4)
    v_mfma_f32_16x16x32_bf16 v[224:227], v[116:119], v[32:35], v[224:227]
    ds_read_b128 v[20:23], v250 offset:22528
    s_waitcnt lgkmcnt(4)
    v_mfma_f32_16x16x32_bf16 v[228:231], v[116:119], v[36:39], v[228:231]
    buffer_load_dwordx4 v[140:143], v1, s[60:63], s14 offen offset:1024 sc1
    s_waitcnt vmcnt(5)
    s_cmp_lt_u32 s3, 4
    s_cbranch_scc1 L_m2
L_m3:
    ds_read_b32 v7, v6 offset:0
    s_waitcnt lgkmcnt(0)
    v_cmp_eq_u32 vcc, 0, v7
    s_cbranch_vccnz L_m3
    ds_read_b128 v[40:43], v2 offset:0
    ds_read_b128 v[44:47], v2 offset:1024
    ds_read_b128 v[48:51], v2 offset:2048
    ds_read_b128 v[52:55], v2 offset:3072
L_m2:
    ds_read_b128 v[24:27], v251 offset:16384
    s_waitcnt lgkmcnt(4)
    v_mfma_f32_16x16x32_bf16 v[216:219], v[120:123], v[8:11], v[216:219]
    ds_read_b128 v[28:31], v251 offset:18432
    s_waitcnt lgkmcnt(4)
    v_mfma_f32_16x16x32_bf16 v[220:223], v[120:123], v[12:15], v[220:223]
    ds_read_b128 v[32:35], v251 offset:20480
    s_waitcnt lgkmcnt(4)
    v_mfma_f32_16x16x32_bf16 v[224:227], v[120:123], v[16:19], v[224:227]
    ds_read_b128 v[36:39], v251 offset:22528
    s_waitcnt lgkmcnt(4)
    v_mfma_f32_16x16x32_bf16 v[228:231], v[120:123], v[20:23], v[228:231]
    buffer_load_dwordx4 v[144:147], v1, s[60:63], s14 offen offset:2048 sc1
    s_waitcnt vmcnt(5)
    ds_read_b128 v[8:11], v250 offset:24576
    s_waitcnt lgkmcnt(4)
    v_mfma_f32_16x16x32_bf16 v[216:219], v[124:127], v[24:27], v[216:219]
    ds_read_b128 v[12:15], v250 offset:26624
    s_waitcnt lgkmcnt(4)
    v_mfma_f32_16x16x32_bf16 v[220:223], v[124:127], v[28:31], v[220:223]
    ds_read_b128 v[16:19], v250 offset:28672
    s_waitcnt lgkmcnt(4)
    v_mfma_f32_16x16x32_bf16 v[224:227], v[124:127], v[32:35], v[224:227]
    ds_read_b128 v[20:23], v250 offset:30720
    s_waitcnt lgkmcnt(4)
    v_mfma_f32_16x16x32_bf16 v[228:231], v[124:127], v[36:39], v[228:231]
    buffer_load_dwordx4 v[148:151], v1, s[60:63], s14 offen offset:3072 sc1
    s_add_u32 s14, s14, 4096
    s_cmp_eq_u32 s14, s13
    s_cselect_b32 s14, s12, s14
    s_waitcnt vmcnt(5)
    ds_read_b128 v[24:27], v251 offset:24576
    s_waitcnt lgkmcnt(4)
    v_mfma_f32_16x16x32_bf16 v[216:219], v[128:131], v[8:11], v[216:219]
    ds_read_b128 v[28:31], v251 offset:26624
    s_waitcnt lgkmcnt(4)
    v_mfma_f32_16x16x32_bf16 v[220:223], v[128:131], v[12:15], v[220:223]
    ds_read_b128 v[32:35], v251 offset:28672
    s_waitcnt lgkmcnt(4)
    v_mfma_f32_16x16x32_bf16 v[224:227], v[128:131], v[16:19], v[224:227]
    ds_read_b128 v[36:39], v251 offset:30720
    s_waitcnt lgkmcnt(4)
    v_mfma_f32_16x16x32_bf16 v[228:231], v[128:131], v[20:23], v[228:231]
    buffer_load_dwordx4 v[152:155], v1, s[60:63], s14 offen offset:0 sc1
    s_waitcnt vmcnt(5)
    ds_read_b128 v[8:11], v250 offset:32768
    s_waitcnt lgkmcnt(4)
    v_mfma_f32_16x16x32_bf16 v[216:219], v[132:135], v[24:27], v[216:219]
    ds_read_b128 v[12:15], v250 offset:34816
    s_waitcnt lgkmcnt(4)
    v_mfma_f32_16x16x32_bf16 v[220:223], v[132:135], v[28:31], v[220:223]
    ds_read_b128 v[16:19], v250 offset:36864
    s_waitcnt lgkmcnt(4)
    v_mfma_f32_16x16x32_bf16 v[224:227], v[132:135], v[32:35], v[224:227]
    ds_read_b128 v[20:23], v250 offset:38912
    s_waitcnt lgkmcnt(4)
    v_mfma_f32_16x16x32_bf16 v[228:231], v[132:135], v[36:39], v[228:231]
    buffer_load_dwordx4 v[156:159], v1, s[60:63], s14 offen offset:1024 sc1
    s_waitcnt vmcnt(5)
    ds_read_b128 v[24:27], v251 offset:32768
    s_waitcnt lgkmcnt(4)
    v_mfma_f32_16x16x32_bf16 v[216:219], v[136:139], v[8:11], v[216:219]
    ds_read_b128 v[28:31], v251 offset:34816
    s_waitcnt lgkmcnt(4)
    v_mfma_f32_16x16x32_bf16 v[220:223], v[136:139], v[12:15], v[220:223]
    ds_read_b128 v[32:35], v251 offset:36864
    s_waitcnt lgkmcnt(4)
    v_mfma_f32_16x16x32_bf16 v[224:227], v[136:139], v[16:19], v[224:227]
    ds_read_b128 v[36:39], v251 offset:38912
    s_waitcnt lgkmcnt(4)
    v_mfma_f32_16x16x32_bf16 v[228:231], v[136:139], v[20:23], v[228:231]
    buffer_load_dwordx4 v[160:163], v1, s[60:63], s14 offen offset:2048 sc1
    s_waitcnt vmcnt(5)
    ds_read_b128 v[8:11], v250 offset:40960
    s_waitcnt lgkmcnt(4)
    v_mfma_f32_16x16x32_bf16 v[216:219], v[140:143], v[24:27], v[216:219]
    ds_read_b128 v[12:15], v250 offset:43008
    s_waitcnt lgkmcnt(4)
    v_mfma_f32_16x16x32_bf16 v[220:223], v[140:143], v[28:31], v[220:223]
    ds_read_b128 v[16:19], v250 offset:45056
    s_waitcnt lgkmcnt(4)
    v_mfma_f32_16x16x32_bf16 v[224:227], v[140:143], v[32:35], v[224:227]
    ds_read_b128 v[20:23], v250 offset:47104
    s_waitcnt lgkmcnt(4)
    v_mfma_f32_16x16x32_bf16 v[228:231], v[140:143], v[36:39], v[228:231]
    buffer_load_dwordx4 v[164:167], v1, s[60:63], s14 offen offset:3072 sc1
    s_add_u32 s14, s14, 4096
    s_cmp_eq_u32 s14, s13
    s_cselect_b32 s14, s12, s14
    s_waitcnt vmcnt(5)
    ds_read_b128 v[24:27], v251 offset:40960
    s_waitcnt lgkmcnt(4)
    v_mfma_f32_16x16x32_bf16 v[216:219], v[144:147], v[8:11], v[216:219]
    ds_read_b128 v[28:31], v251 offset:43008
    s_waitcnt lgkmcnt(4)
    v_mfma_f32_16x16x32_bf16 v[220:223], v[144:147], v[12:15], v[220:223]
    ds_read_b128 v[32:35], v251 offset:45056
    s_waitcnt lgkmcnt(4)
    v_mfma_f32_16x16x32_bf16 v[224:227], v[144:147], v[16:19], v[224:227]
    ds_read_b128 v[36:39], v251 offset:47104
    s_waitcnt lgkmcnt(4)
    v_mfma_f32_16x16x32_bf16 v[228:231], v[144:147], v[20:23], v[228:231]
    buffer_load_dwordx4 v[168:171], v1, s[60:63], s14 offen offset:0 sc1
    s_waitcnt vmcnt(5)
    ds_read_b128 v[8:11], v250 offset:49152
    s_waitcnt lgkmcnt(4)
    v_mfma_f32_16x16x32_bf16 v[216:219], v[148:151], v[24:27], v[216:219]
    ds_read_b128 v[12:15], v250 offset:51200
    s_waitcnt lgkmcnt(4)
    v_mfma_f32_16x16x32_bf16 v[220:223], v[148:151], v[28:31], v[220:223]
    ds_read_b128 v[16:19], v250 offset:53248
    s_waitcnt lgkmcnt(4)
    v_mfma_f32_16x16x32_bf16 v[224:227], v[148:151], v[32:35], v[224:227]
    ds_read_b128 v[20:23], v250 offset:55296
    s_waitcnt lgkmcnt(4)
    v_mfma_f32_16x16x32_bf16 v[228:231], v[148:151], v[36:39], v[228:231]
    buffer_load_dwordx4 v[172:175], v1, s[60:63], s14 offen offset:1024 sc1
    s_waitcnt vmcnt(5)
    ds_read_b128 v[24:27], v251 offset:49152
    s_waitcnt lgkmcnt(4)
    v_mfma_f32_16x16x32_bf16 v[216:219], v[152:155], v[8:11], v[216:219]
    ds_read_b128 v[28:31], v251 offset:51200
    s_waitcnt lgkmcnt(4)
    v_mfma_f32_16x16x32_bf16 v[220:223], v[152:155], v[12:15], v[220:223]
    ds_read_b128 v[32:35], v251 offset:53248
    s_waitcnt lgkmcnt(4)
    v_mfma_f32_16x16x32_bf16 v[224:227], v[152:155], v[16:19], v[224:227]
    ds_read_b128 v[36:39], v251 offset:55296
    s_waitcnt lgkmcnt(4)
    v_mfma_f32_16x16x32_bf16 v[228:231], v[152:155], v[20:23], v[228:231]
    buffer_load_dwordx4 v[176:179], v1, s[60:63], s14 offen offset:2048 sc1
    s_waitcnt vmcnt(5)
    ds_read_b128 v[8:11], v250 offset:57344
    s_waitcnt lgkmcnt(4)
    v_mfma_f32_16x16x32_bf16 v[216:219], v[156:159], v[24:27], v[216:219]
    ds_read_b128 v[12:15], v250 offset:59392
    s_waitcnt lgkmcnt(4)
    v_mfma_f32_16x16x32_bf16 v[220:223], v[156:159], v[28:31], v[220:223]
    ds_read_b128 v[16:19], v250 offset:61440
    s_waitcnt lgkmcnt(4)
    v_mfma_f32_16x16x32_bf16 v[224:227], v[156:159], v[32:35], v[224:227]
    ds_read_b128 v[20:23], v250 offset:63488
    s_waitcnt lgkmcnt(4)
    v_mfma_f32_16x16x32_bf16 v[228:231], v[156:159], v[36:39], v[228:231]
    buffer_load_dwordx4 v[180:183], v1, s[60:63], s14 offen offset:3072 sc1
    s_add_u32 s14, s14, 4096
    s_cmp_eq_u32 s14, s13
    s_cselect_b32 s14, s12, s14
    s_waitcnt vmcnt(5)
    ds_read_b128 v[24:27], v251 offset:57344
    s_waitcnt lgkmcnt(4)
    v_mfma_f32_16x16x32_bf16 v[216:219], v[160:163], v[8:11], v[216:219]
    ds_read_b128 v[28:31], v251 offset:59392
    s_waitcnt lgkmcnt(4)
    v_mfma_f32_16x16x32_bf16 v[220:223], v[160:163], v[12:15], v[220:223]
    ds_read_b128 v[32:35], v251 offset:61440
    s_waitcnt lgkmcnt(4)
    v_mfma_f32_16x16x32_bf16 v[224:227], v[160:163], v[16:19], v[224:227]
    ds_read_b128 v[36:39], v251 offset:63488
    s_waitcnt lgkmcnt(4)
    v_mfma_f32_16x16x32_bf16 v[228:231], v[160:163], v[20:23], v[228:231]
    buffer_load_dwordx4 v[184:187], v1, s[60:63], s14 offen offset:0 sc1
    s_waitcnt vmcnt(5)
    ds_read_b128 v[8:11], v248 offset:0
    s_waitcnt lgkmcnt(4)
    v_mfma_f32_16x16x32_bf16 v[216:219], v[164:167], v[24:27], v[216:219]
    ds_read_b128 v[12:15], v248 offset:2048
    s_waitcnt lgkmcnt(4)
    v_mfma_f32_16x16x32_bf16 v[220:223], v[164:167], v[28:31], v[220:223]
    ds_read_b128 v[16:19], v248 offset:4096
    s_waitcnt lgkmcnt(4)
    v_mfma_f32_16x16x32_bf16 v[224:227], v[164:167], v[32:35], v[224:227]
    ds_read_b128 v[20:23], v248 offset:6144
    s_waitcnt lgkmcnt(4)
    v_mfma_f32_16x16x32_bf16 v[228:231], v[164:167], v[36:39], v[228:231]
    buffer_load_dwordx4 v[188:191], v1, s[60:63], s14 offen offset:1024 sc1
    s_waitcnt vmcnt(5)
    ds_read_b128 v[24:27], v249 offset:0
    s_waitcnt lgkmcnt(4)
    v_mfma_f32_16x16x32_bf16 v[216:219], v[168:171], v[8:11], v[216:219]
    ds_read_b128 v[28:31], v249 offset:2048
    s_waitcnt lgkmcnt(4)
    v_mfma_f32_16x16x32_bf16 v[220:223], v[168:171], v[12:15], v[220:223]
    ds_read_b128 v[32:35], v249 offset:4096
    s_waitcnt lgkmcnt(4)
    v_mfma_f32_16x16x32_bf16 v[224:227], v[168:171], v[16:19], v[224:227]
    ds_read_b128 v[36:39], v249 offset:6144
    s_waitcnt lgkmcnt(4)
    v_mfma_f32_16x16x32_bf16 v[228:231], v[168:171], v[20:23], v[228:231]
    buffer_load_dwordx4 v[192:195], v1, s[60:63], s14 offen offset:2048 sc1
    s_waitcnt vmcnt(5)
    ds_read_b128 v[8:11], v248 offset:8192
    s_waitcnt lgkmcnt(4)
    v_mfma_f32_16x16x32_bf16 v[216:219], v[172:175], v[24:27], v[216:219]
    ds_read_b128 v[12:15], v248 offset:10240
    s_waitcnt lgkmcnt(4)
    v_mfma_f32_16x16x32_bf16 v[220:223], v[172:175], v[28:31], v[220:223]
    ds_read_b128 v[16:19], v248 offset:12288
    s_waitcnt lgkmcnt(4)
    v_mfma_f32_16x16x32_bf16 v[224:227], v[172:175], v[32:35], v[224:227]
    ds_read_b128 v[20:23], v248 offset:14336
    s_waitcnt lgkmcnt(4)
    v_mfma_f32_16x16x32_bf16 v[228:231], v[172:175], v[36:39], v[228:231]
    buffer_load_dwordx4 v[196:199], v1, s[60:63], s14 offen offset:3072 sc1
    s_waitcnt vmcnt(5)
    ds_read_b128 v[24:27], v249 offset:8192
    s_waitcnt lgkmcnt(4)
    v_mfma_f32_16x16x32_bf16 v[216:219], v[176:179], v[8:11], v[216:219]
    ds_read_b128 v[28:31], v249 offset:10240
    s_waitcnt lgkmcnt(4)
    v_mfma_f32_16x16x32_bf16 v[220:223], v[176:179], v[12:15], v[220:223]
    ds_read_b128 v[32:35], v249 offset:12288
    s_waitcnt lgkmcnt(4)
    v_mfma_f32_16x16x32_bf16 v[224:227], v[176:179], v[16:19], v[224:227]
    ds_read_b128 v[36:39], v249 offset:14336
    s_waitcnt lgkmcnt(4)
    v_mfma_f32_16x16x32_bf16 v[228:231], v[176:179], v[20:23], v[228:231]
    s_waitcnt vmcnt(4)
    ds_read_b128 v[8:11], v248 offset:16384
    s_waitcnt lgkmcnt(4)
    v_mfma_f32_16x16x32_bf16 v[216:219], v[180:183], v[24:27], v[216:219]
    ds_read_b128 v[12:15], v248 offset:18432
    s_waitcnt lgkmcnt(4)
    v_mfma_f32_16x16x32_bf16 v[220:223], v[180:183], v[28:31], v[220:223]
    ds_read_b128 v[16:19], v248 offset:20480
    s_waitcnt lgkmcnt(4)
    v_mfma_f32_16x16x32_bf16 v[224:227], v[180:183], v[32:35], v[224:227]
    ds_read_b128 v[20:23], v248 offset:22528
    s_waitcnt lgkmcnt(4)
    v_mfma_f32_16x16x32_bf16 v[228:231], v[180:183], v[36:39], v[228:231]
    s_waitcnt vmcnt(3)
    ds_read_b128 v[24:27], v249 offset:16384
    s_waitcnt lgkmcnt(4)
    v_mfma_f32_16x16x32_bf16 v[216:219], v[184:187], v[8:11], v[216:219]
    ds_read_b128 v[28:31], v249 offset:18432
    s_waitcnt lgkmcnt(4)
    v_mfma_f32_16x16x32_bf16 v[220:223], v[184:187], v[12:15], v[220:223]
    ds_read_b128 v[32:35], v249 offset:20480
    s_waitcnt lgkmcnt(4)
    v_mfma_f32_16x16x32_bf16 v[224:227], v[184:187], v[16:19], v[224:227]
    ds_read_b128 v[36:39], v249 offset:22528
    s_waitcnt lgkmcnt(4)
    v_mfma_f32_16x16x32_bf16 v[228:231], v[184:187], v[20:23], v[228:231]
    s_waitcnt vmcnt(2)
    ds_read_b128 v[8:11], v248 offset:24576
    s_waitcnt lgkmcnt(4)
    v_mfma_f32_16x16x32_bf16 v[216:219], v[188:191], v[24:27], v[216:219]
    ds_read_b128 v[12:15], v248 offset:26624
    s_waitcnt lgkmcnt(4)
    v_mfma_f32_16x16x32_bf16 v[220:223], v[188:191], v[28:31], v[220:223]
    ds_read_b128 v[16:19], v248 offset:28672
    s_waitcnt lgkmcnt(4)
    v_mfma_f32_16x16x32_bf16 v[224:227], v[188:191], v[32:35], v[224:227]
    ds_read_b128 v[20:23], v248 offset:30720
    s_waitcnt lgkmcnt(4)
    v_mfma_f32_16x16x32_bf16 v[228:231], v[188:191], v[36:39], v[228:231]
    s_waitcnt vmcnt(1)
    ds_read_b128 v[24:27], v249 offset:24576
    s_waitcnt lgkmcnt(4)
    v_mfma_f32_16x16x32_bf16 v[216:219], v[192:195], v[8:11], v[216:219]
    ds_read_b128 v[28:31], v249 offset:26624
    s_waitcnt lgkmcnt(4)
    v_mfma_f32_16x16x32_bf16 v[220:223], v[192:195], v[12:15], v[220:223]
    ds_read_b128 v[32:35], v249 offset:28672
    s_waitcnt lgkmcnt(4)
    v_mfma_f32_16x16x32_bf16 v[224:227], v[192:195], v[16:19], v[224:227]
    ds_read_b128 v[36:39], v249 offset:30720
    s_waitcnt lgkmcnt(4)
    v_mfma_f32_16x16x32_bf16 v[228:231], v[192:195], v[20:23], v[228:231]
    s_waitcnt vmcnt(0)
    s_waitcnt lgkmcnt(3)
    v_mfma_f32_16x16x32_bf16 v[216:219], v[196:199], v[24:27], v[216:219]
    s_waitcnt lgkmcnt(2)
    v_mfma_f32_16x16x32_bf16 v[220:223], v[196:199], v[28:31], v[220:223]
    s_waitcnt lgkmcnt(1)
    v_mfma_f32_16x16x32_bf16 v[224:227], v[196:199], v[32:35], v[224:227]
    s_waitcnt lgkmcnt(0)
    v_mfma_f32_16x16x32_bf16 v[228:231], v[196:199], v[36:39], v[228:231]
    s_cmp_ge_u32 s3, 4
    s_cbranch_scc1 L_m4
    v_add_f32 v56, v216, v40
    s_nop 0
    v_add_f32 v57, v220, v44
    s_nop 0
    v_add_f32 v58, v224, v48
    s_nop 0
    v_add_f32 v59, v228, v52
    buffer_store_dwordx4 v[56:59], v3, s[64:67], s8 offen sc1
    s_add_u32 s8, s8, 4608
    v_add_f32 v60, v217, v41
    v_add_f32 v61, v221, v45
    v_add_f32 v62, v225, v49
    v_add_f32 v63, v229, v53
    buffer_store_dwordx4 v[60:63], v3, s[64:67], s8 offen sc1
    s_add_u32 s8, s8, 4608
    v_add_f32 v64, v218, v42
    v_add_f32 v65, v222, v46
    v_add_f32 v66, v226, v50
    v_add_f32 v67, v230, v54
    buffer_store_dwordx4 v[64:67], v3, s[64:67], s8 offen sc1
    s_add_u32 s8, s8, 4608
    v_add_f32 v68, v219, v43
    v_add_f32 v69, v223, v47
    v_add_f32 v70, v227, v51
    v_add_f32 v71, v231, v55
    buffer_store_dwordx4 v[68:71], v3, s[64:67], s8 offen sc1
    s_branch L_m5
L_m4:
    v_add_f32 v56, v216, v40
    s_nop 0
    v_add_f32 v57, v220, v44
    s_nop 0
    v_add_f32 v58, v224, v48
    s_nop 0
    v_add_f32 v59, v228, v52
    buffer_store_dwordx4 v[56:59], v3, s[64:67], s8 offen
    s_add_u32 s8, s8, 4608
    v_add_f32 v60, v217, v41
    v_add_f32 v61, v221, v45
    v_add_f32 v62, v225, v49
    v_add_f32 v63, v229, v53
    buffer_store_dwordx4 v[60:63], v3, s[64:67], s8 offen
    s_add_u32 s8, s8, 4608
    v_add_f32 v64, v218, v42
    v_add_f32 v65, v222, v46
    v_add_f32 v66, v226, v50
    v_add_f32 v67, v230, v54
    buffer_store_dwordx4 v[64:67], v3, s[64:67], s8 offen
    s_add_u32 s8, s8, 4608
    v_add_f32 v68, v219, v43
    v_add_f32 v69, v223, v47
    v_add_f32 v70, v227, v51
    v_add_f32 v71, v231, v55
    buffer_store_dwordx4 v[68:71], v3, s[64:67], s8 offen
L_m5:
    s_endpgm
L_H:
    s_sub_u32 s4, s2, 248
    s_lshl_b32 s4, s4, 3
    s_add_u32 s4, s4, s3
    s_cmp_gt_u32 s4, 9
    s_cbranch_scc1 L_end
    v_mov_b32 v2, 0
    v_lshlrev_b32 v9, 1, v0
    s_lshl_b32 s6, s4, 7
    s_waitcnt lgkmcnt(0)
    s_mov_b32 s60, s52
    s_mov_b32 s61, s53
    s_mov_b32 s62, 0x10000000
    s_mov_b32 s63, 0x20000
    s_mov_b32 s72, s50
    s_mov_b32 s73, s51
    s_mov_b32 s74, 0x100
    s_mov_b32 s75, 0x20000
    s_cmp_lg_u32 s4, 9
    s_cbranch_scc1 L_H_tab
    s_mov_b32 s9, 0x580000
    s_mov_b64 exec, 1
    buffer_load_dword v3, v2, s[60:63], s9 offen sc1
    s_waitcnt vmcnt(0)
    v_add_u32 v3, 1, v3
    v_max_u32 v3, 1, v3
    buffer_store_dword v3, v2, s[72:75], 0 offen sc1
    buffer_store_dword v3, v2, s[60:63], s9 offen sc1
    s_endpgm
L_H_tab:
    s_mov_b32 s56, s32
    s_mov_b32 s57, s33
    s_mov_b32 s58, 0x480
    s_mov_b32 s59, 0x20000
    buffer_load_ushort v110, v9, s[56:59], s6 offen
    s_mov_b32 s56, s34
    s_mov_b32 s57, s35
    s_mov_b32 s58, 0x480
    s_mov_b32 s59, 0x20000
    buffer_load_ushort v111, v9, s[56:59], s6 offen
    s_mov_b32 s56, s44
    s_mov_b32 s57, s45
    s_mov_b32 s58, 0x480
    s_mov_b32 s59, 0x20000
    buffer_load_ushort v112, v9, s[56:59], s6 offen
    s_mov_b32 s76, 0x3fb8aa3b
    s_mov_b32 s77, 0x32a57060
    s_mov_b32 s78, 0x3f317218
    v_and_b32 v114, 3, v0
    v_lshrrev_b32 v115, 2, v0
    v_lshlrev_b32 v102, 8, v114
    v_lshl_add_u32 v102, v115, 4, v102
    v_lshlrev_b32 v103, 7, v114
    v_lshl_add_u32 v103, v115, 3, v103
    v_lshlrev_b32 v101, 3, v0
    s_lshl_b32 s8, s4, 13
    s_add_u32 s8, s8, 0x5a0000
    s_add_u32 s10, s8, 4096
    s_waitcnt vmcnt(0)
    v_lshlrev_b32 v110, 16, v110
    v_lshlrev_b32 v111, 16, v111
    v_lshlrev_b32 v112, 16, v112
    v_mul_f32 v104, s76, v112
    v_fma_f32 v105, v112, s76, -v104
    v_fma_f32 v105, v112, s77, v105
    v_exp_f32 v104, v104
    v_mul_f32 v105, s78, v105
    v_fma_f32 v104, v104, v105, v104
    v_cvt_pk_bf16_f32 v104, v104, v104
    v_and_b32 v112, 0xffff0000, v104
    v_mul_f32 v104, v112, v110
    v_mul_f32 v105, v112, v111
    v_mul_f32 v104, s76, v104
    v_mul_f32 v105, 0.15915494, v105
    v_exp_f32 v104, v104
    v_fract_f32 v105, v105
    v_cos_f32 v106, v105
    v_sin_f32 v107, v105
    v_mul_f32 v122, v104, v106
    v_mul_f32 v123, v104, v107
    v_pk_mul_f32 v[124:125], v[122:123], v[122:123] op_sel:[0,0] op_sel_hi:[1,0]
    v_pk_fma_f32 v[124:125], v[122:123], v[122:123], v[124:125] op_sel:[1,1,0] op_sel_hi:[0,1,1] neg_lo:[1,0,0]
    v_pk_mul_f32 v[128:129], v[124:125], v[124:125] op_sel:[0,0] op_sel_hi:[1,0]
    v_pk_fma_f32 v[128:129], v[124:125], v[124:125], v[128:129] op_sel:[1,1,0] op_sel_hi:[0,1,1] neg_lo:[1,0,0]
    v_pk_mul_f32 v[136:137], v[128:129], v[128:129] op_sel:[0,0] op_sel_hi:[1,0]
    v_pk_fma_f32 v[136:137], v[128:129], v[128:129], v[136:137] op_sel:[1,1,0] op_sel_hi:[0,1,1] neg_lo:[1,0,0]
    v_mov_b32 v176, v122
    v_mov_b32 v177, v123
    v_mov_b32 v178, v128
    v_mov_b32 v179, v129
    buffer_store_dwordx4 v[176:179], v102, s[60:63], s10 offen sc1
    buffer_store_dwordx2 v[136:137], v101, s[60:63], s10 offen offset:1536 sc1
    v_mul_f32 v104, v110, v110
    v_fmac_f32 v104, v111, v111
    v_rcp_f32 v104, v104
    v_add_f32 v106, -1.0, v122
    v_mov_b32 v107, v123
    v_add_f32 v104, v104, v104
    v_mul_f32 v108, v104, v110
    v_mul_f32 v109, -v104, v111
    v_pk_mul_f32 v[116:117], v[106:107], v[108:109] op_sel:[0,0] op_sel_hi:[1,0]
    v_pk_fma_f32 v[116:117], v[106:107], v[108:109], v[116:117] op_sel:[1,1,0] op_sel_hi:[0,1,1] neg_lo:[1,0,0]
    buffer_store_dwordx2 v[116:117], v103, s[60:63], s10 offen offset:1024 sc1
    v_pk_mul_f32 v[142:143], v[116:117], v[122:123] op_sel:[0,0] op_sel_hi:[1,0]
    v_pk_fma_f32 v[142:143], v[116:117], v[122:123], v[142:143] op_sel:[1,1,0] op_sel_hi:[0,1,1] neg_lo:[1,0,0]
    v_pk_mul_f32 v[144:145], v[116:117], v[124:125] op_sel:[0,0] op_sel_hi:[1,0]
    v_pk_fma_f32 v[144:145], v[116:117], v[124:125], v[144:145] op_sel:[1,1,0] op_sel_hi:[0,1,1] neg_lo:[1,0,0]
    v_pk_mul_f32 v[146:147], v[142:143], v[124:125] op_sel:[0,0] op_sel_hi:[1,0]
    v_pk_fma_f32 v[146:147], v[142:143], v[124:125], v[146:147] op_sel:[1,1,0] op_sel_hi:[0,1,1] neg_lo:[1,0,0]
    v_pk_mul_f32 v[148:149], v[116:117], v[128:129] op_sel:[0,0] op_sel_hi:[1,0]
    v_pk_fma_f32 v[148:149], v[116:117], v[128:129], v[148:149] op_sel:[1,1,0] op_sel_hi:[0,1,1] neg_lo:[1,0,0]
    v_pk_mul_f32 v[150:151], v[142:143], v[128:129] op_sel:[0,0] op_sel_hi:[1,0]
    v_pk_fma_f32 v[150:151], v[142:143], v[128:129], v[150:151] op_sel:[1,1,0] op_sel_hi:[0,1,1] neg_lo:[1,0,0]
    v_pk_mul_f32 v[152:153], v[144:145], v[128:129] op_sel:[0,0] op_sel_hi:[1,0]
    v_pk_fma_f32 v[152:153], v[144:145], v[128:129], v[152:153] op_sel:[1,1,0] op_sel_hi:[0,1,1] neg_lo:[1,0,0]
    v_pk_mul_f32 v[154:155], v[146:147], v[128:129] op_sel:[0,0] op_sel_hi:[1,0]
    v_pk_fma_f32 v[154:155], v[146:147], v[128:129], v[154:155] op_sel:[1,1,0] op_sel_hi:[0,1,1] neg_lo:[1,0,0]
    v_pk_mul_f32 v[156:157], v[148:149], v[128:129] op_sel:[0,0] op_sel_hi:[1,0]
    v_pk_fma_f32 v[156:157], v[148:149], v[128:129], v[156:157] op_sel:[1,1,0] op_sel_hi:[0,1,1] neg_lo:[1,0,0]
    v_mov_b32 v160, v142
    v_mov_b32 v161, v150
    v_mov_b32 v162, v143
    v_mov_b32 v163, v151
    buffer_store_dwordx4 v[160:163], v102, s[60:63], s8 offen offset:0 sc1
    v_mov_b32 v164, v144
    v_mov_b32 v165, v152
    v_mov_b32 v166, v145
    v_mov_b32 v167, v153
    buffer_store_dwordx4 v[164:167], v102, s[60:63], s8 offen offset:1024 sc1
    v_mov_b32 v168, v146
    v_mov_b32 v169, v154
    v_mov_b32 v170, v147
    v_mov_b32 v171, v155
    buffer_store_dwordx4 v[168:171], v102, s[60:63], s8 offen offset:2048 sc1
    v_mov_b32 v172, v148
    v_mov_b32 v173, v156
    v_mov_b32 v174, v149
    v_mov_b32 v175, v157
    buffer_store_dwordx4 v[172:175], v102, s[60:63], s8 offen offset:3072 sc1
    v_mov_b32 v3, 1
    s_lshl_b32 s6, s4, 2
    s_waitcnt vmcnt(0)
    s_mov_b64 exec, 1
    buffer_store_dword v3, v2, s[72:75], s6 offen offset:4 sc1
    s_endpgm
L_A:
    s_lshr_b32 s6, s2, 1
    s_cmp_eq_u32 s6, 124
    s_cbranch_scc1 L_H
    s_sub_u32 s6, s2, 144
    s_and_b32 s7, s6, 7
    s_lshr_b32 s79, s6, 3
    s_mul_i32 s4, s7, 13
    s_max_u32 s6, s7, 2
    s_min_u32 s6, s6, 6
    s_add_u32 s4, s4, s6
    s_sub_u32 s4, s4, 2
    s_add_u32 s4, s4, s79
    s_mul_i32 s6, s4, 0x5556
    s_lshr_b32 s6, s6, 16
    s_mul_i32 s8, s6, 3
    s_sub_u32 s70, s4, s8
    s_lshl_b32 s6, s6, 4
    s_mul_i32 s8, s70, 6
    s_add_u32 s4, s6, s8
    s_sub_u32 s6, s3, 2
    s_cmp_ge_u32 s3, 6
    s_cselect_b32 s5, s6, s3
    s_add_u32 s6, s4, s5
    v_lshlrev_b32 v1, 2, v0
    s_lshl_b32 s8, s6, 8
    s_lshl_b32 s9, s6, 1
    v_mov_b32 v2, 0
    s_lshl_b32 s10, s3, 8
    s_add_u32 s6, s79, s3
    s_and_b32 s78, s6, 7
    s_lshl_b32 s6, s78, 8
    v_lshl_add_u32 v3, v0, 2, s6
    v_mul_u32_u24 v3, 1152, v3
    s_lshl_b32 s11, s4, 1
    s_mov_b32 s12, 0x3fb8aa3b
    s_mov_b32 s13, 0x32a57060
    s_mov_b32 s14, 0x3f317218
    s_mul_i32 s15, s3, 8768
    s_mov_b32 m0, s15
    s_add_u32 s15, s15, 27520
    v_mov_b32 v216, 0
    v_mov_b32 v217, 0
    v_mov_b32 v218, 0
    v_mov_b32 v219, 0
    v_mov_b32 v19, 27456
    ds_write_b128 v19, v[216:219]
    ds_write_b128 v19, v[216:219] offset:16
    s_waitcnt lgkmcnt(0)
    s_mov_b32 s60, s26
    s_mov_b32 s61, s27
    s_mov_b32 s62, 0x480
    s_mov_b32 s63, 0x20000
    buffer_load_ushort v12, v2, s[60:63], s9 offen
    s_mov_b32 s60, s22
    s_mov_b32 s61, s23
    s_mov_b32 s62, 0x24000
    s_mov_b32 s63, 0x20000
    buffer_load_dword v10, v1, s[60:63], s8 offen
    s_mov_b32 s60, s24
    s_mov_b32 s61, s25
    s_mov_b32 s62, 0x24000
    s_mov_b32 s63, 0x20000
    buffer_load_dword v11, v1, s[60:63], s8 offen
    s_mov_b32 s60, s18
    s_mov_b32 s61, s19
    s_mov_b32 s62, 0x24000
    s_mov_b32 s63, 0x20000
    buffer_load_dword v8, v1, s[60:63], s8 offen
    s_mov_b32 s60, s20
    s_mov_b32 s61, s21
    s_mov_b32 s62, 0x24000
    s_mov_b32 s63, 0x20000
    buffer_load_dword v9, v1, s[60:63], s8 offen
    s_mov_b32 s60, s28
    s_mov_b32 s61, s29
    s_mov_b32 s62, 0x480
    s_mov_b32 s63, 0x20000
    buffer_load_ushort v13, v2, s[60:63], s9 offen
    s_mul_i32 s6, s79, 158
    s_mul_i32 s76, s3, 20
    s_add_u32 s6, s6, s76
    v_lshrrev_b32 v249, 1, v0
    v_min_u32 v249, 19, v249
    v_add_u32 v249, s6, v249
    v_mul_u32_u24 v249, 1152, v249
    v_and_b32 v21, 1, v0
    v_lshl_add_u32 v249, v21, 7, v249
    s_lshl_b32 s71, s7, 7
    s_mov_b32 s56, s16
    s_mov_b32 s57, s17
    s_mov_b32 s58, 0x240000
    s_mov_b32 s59, 0x20000
    s_lshl_b32 s6, s79, 3
    s_add_u32 s6, s6, s3
    s_mul_i32 s71, s6, 6400
    s_barrier
    s_mov_b32 s64, s48
    s_mov_b32 s65, s49
    s_mov_b32 s66, 0x900000
    s_mov_b32 s67, 0x20000
    v_and_b32 v4, 15, v0
    v_lshrrev_b32 v5, 4, v0
    v_and_b32 v6, 31, v0
    v_lshrrev_b32 v7, 5, v0
    s_mul_i32 s6, s5, 4576
    v_lshl_add_u32 v14, v0, 4, s6
    s_mov_b64 exec, 0x3fffffff
    ds_write_b128 v14, v[216:219]
    s_mov_b64 exec, -1
    v_mul_u32_u24 v15, 272, v6
    v_lshl_add_u32 v15, v7, 4, v15
    v_add_u32 v15, s15, v15
    v_lshrrev_b32 v16, 2, v6
    v_mov_b32 v17, 0x3020100
    v_cmp_eq_u32 vcc, 1, v16
    v_mov_b32 v18, 0xb0a0909
    s_nop 0
    v_cndmask_b32 v17, v17, v18, vcc
    v_cmp_eq_u32 vcc, 2, v16
    v_mov_b32 v18, 0x7060504
    s_nop 0
    v_cndmask_b32 v17, v17, v18, vcc
    v_cmp_eq_u32 vcc, 3, v16
    v_mov_b32 v18, 0xd0c0b0b
    s_nop 0
    v_cndmask_b32 v17, v17, v18, vcc
    v_cmp_eq_u32 vcc, 4, v16
    v_mov_b32 v18, 0x100f0e08
    s_nop 0
    v_cndmask_b32 v17, v17, v18, vcc
    v_cmp_eq_u32 vcc, 5, v16
    v_mov_b32 v18, 0x1312110d
    s_nop 0
    v_cndmask_b32 v17, v17, v18, vcc
    v_cmp_eq_u32 vcc, 6, v16
    v_mov_b32 v18, 0x19181514
    s_nop 0
    v_cndmask_b32 v17, v17, v18, vcc
    v_cmp_eq_u32 vcc, 7, v16
    v_mov_b32 v18, 0x1b1a1716
    s_nop 0
    v_cndmask_b32 v17, v17, v18, vcc
    v_and_b32 v16, 3, v6
    v_lshlrev_b32 v16, 3, v16
    v_lshrrev_b32 v17, v16, v17
    v_and_b32 v17, 0xff, v17
    v_mul_u32_u24 v16, 272, v17
    v_lshl_add_u32 v16, v7, 4, v16
    v_add_u32 v16, s15, v16
    s_mov_b32 s68, 0x05040100
    s_mov_b32 s69, 0x07060302
    v_lshrrev_b32 v236, 1, v0
    v_lshlrev_b32 v236, 4, v236
    v_and_b32 v237, 1, v0
    v_xor_b32 v23, 1, v237
    v_lshl_add_u32 v236, v23, 3, v236
    s_lshl_b32 s6, s78, 9
    s_add_u32 s6, s6, 480
    v_add_u32 v236, s6, v236
    s_and_b32 s6, s3, 1
    s_lshl_b32 s6, s6, 2
    v_add_u32 v19, s6, v19
    s_and_b32 s6, s3, 1
    s_cmp_ge_u32 s3, 6
    s_cselect_b32 s6, s6, s3
    s_cselect_b32 s77, 384, 0
    s_cselect_b32 s54, 17472, 64
    s_cselect_b32 s55, 9280, 0
    s_sub_u32 s55, s55, 64
    s_mul_i32 s75, s6, 8768
    s_add_u32 s75, s75, 27520
    s_add_u32 s75, s75, s77
    s_mul_i32 s76, s6, 4576
    s_add_u32 s76, s76, 496
    s_sub_u32 s76, s76, s77
    s_lshl_b32 s9, s6, 13
    s_add_u32 s9, s9, 97664
    v_lshl_add_u32 v22, v5, 3, v4
    v_sub_u32 v238, 15, v22
    v_add_u32 v22, 1, v22
    v_and_b32 v22, 0xfffe, v22
    v_lshlrev_b32 v22, 1, v22
    v_and_b32 v23, 1, v4
    v_xor_b32 v23, 1, v23
    v_mul_u32_u24 v23, 4160, v23
    v_add3_u32 v240, v22, v23, s75
    v_add_u32 v241, 1024, v240
    v_add_u32 v242, 2048, v240
    v_add_u32 v243, 3072, v240
    v_lshlrev_b32 v22, 1, v4
    v_sub_u32 v22, v22, v5
    v_lshlrev_b32 v22, 4, v22
    v_add_u32 v244, s76, v22
    v_lshl_add_u32 v245, v0, 4, s9
    v_lshlrev_b32 v246, 6, v4
    v_lshl_add_u32 v246, v5, 4, v246
    v_add_u32 v246, s15, v246
    v_lshrrev_b32 v22, 1, v0
    v_and_b32 v23, 1, v0
    v_mul_u32_u24 v247, 26304, v23
    v_lshl_add_u32 v247, v22, 2, v247
    s_lshl_b32 s6, s3, 10
    s_add_u32 s6, s6, 27520
    v_add_u32 v247, s6, v247
    v_add_u32 v22, s10, v22
    v_mul_u32_u24 v248, 4608, v22
    v_mul_u32_u24 v23, 12, v23
    v_add_u32 v248, v248, v23
    s_lshl_b32 s8, s4, 2
    s_lshr_b32 s79, s3, 1
    v_mov_b32 v220, 0
    v_mov_b32 v221, 0
    v_mov_b32 v222, 0
    v_mov_b32 v223, 0
    v_mov_b32 v224, 0
    v_mov_b32 v225, 0
    v_mov_b32 v226, 0
    v_mov_b32 v227, 0
    v_mov_b32 v228, 0
    v_mov_b32 v229, 0
    v_mov_b32 v230, 0
    v_mov_b32 v231, 0
    v_mov_b32 v232, 0
    v_mov_b32 v233, 0
    v_mov_b32 v234, 0
    v_mov_b32 v235, 0
    s_mov_b32 s72, 0x4238aa3b
    s_mov_b32 s74, 0x40a2f983
    s_mov_b32 s75, 0x7fff7fff
    s_cmp_ge_u32 s3, 6
    s_cselect_b32 s7, 1, 0
    s_lshr_b32 s6, s3, 1
    s_cmp_eq_u32 s6, 2
    s_cselect_b32 s77, 1, 2
    s_waitcnt vmcnt(3)
    v_and_b32 v20, s75, v10
    v_and_b32 v21, s75, v11
    v_pk_max_u16 v20, v20, v21
    v_lshlrev_b32 v12, 16, v12
    v_lshrrev_b32 v21, 16, v20
    v_and_b32 v20, 0xffff, v20
    v_max_u32 v22, v20, v21
    s_nop 1
    v_max_u32_dpp v22, v22, v22 row_shr:1 row_mask:0xf bank_mask:0xf
    s_nop 1
    v_max_u32_dpp v22, v22, v22 row_shr:2 row_mask:0xf bank_mask:0xf
    s_nop 1
    v_max_u32_dpp v22, v22, v22 row_shr:4 row_mask:0xf bank_mask:0xf
    s_nop 1
    v_max_u32_dpp v22, v22, v22 row_shr:8 row_mask:0xf bank_mask:0xf
    s_nop 1
    v_max_u32_dpp v22, v22, v22 row_bcast:15 row_mask:0xf bank_mask:0xf
    s_nop 1
    v_max_u32_dpp v22, v22, v22 row_bcast:31 row_mask:0xf bank_mask:0xf
    v_mul_f32 v20, s12, v12
    v_fma_f32 v21, v12, s12, -v20
    v_fma_f32 v21, v12, s13, v21
    v_exp_f32 v20, v20
    v_mul_f32 v21, s14, v21
    v_fma_f32 v20, v20, v21, v20
    v_cvt_pk_bf16_f32 v20, v20, v20
    v_and_b32 v12, 0xffff0000, v20
    v_readlane_b32 s6, v22, 63
    s_lshr_b32 s6, s6, 7
    s_max_u32 s6, s6, 14
    s_min_u32 s6, s6, 254
    s_sub_u32 s73, 267, s6
    s_lshl_b32 s73, s73, 23
    s_sub_u32 s6, s6, 12
    s_lshl_b32 s6, s6, 23
    v_mul_f32 v17, s6, v12
    s_waitcnt vmcnt(0)
    s_cmp_lg_u32 s70, 2
    s_cbranch_scc1 L_A_half
    s_cmp_lt_u32 s3, 4
    s_cbranch_scc1 L_A_half
    buffer_load_dwordx2 v[200:201], v3, s[56:59], s11 offen offset:0
    buffer_load_dwordx2 v[204:205], v3, s[56:59], s11 offen offset:1152
    buffer_load_dwordx2 v[208:209], v3, s[56:59], s11 offen offset:2304
    buffer_load_dwordx2 v[212:213], v3, s[56:59], s11 offen offset:3456
    s_cmp_ge_u32 s3, 6
    s_cbranch_scc1 L_A_give2
    s_branch L_A_tr
L_A_half:
    s_cmp_eq_u32 s7, 0
    s_cselect_b32 s6, 16, 0
    v_lshlrev_b32 v24, s6, v8
    v_lshlrev_b32 v25, s6, v9
    v_lshlrev_b32 v26, s6, v10
    v_lshlrev_b32 v27, s6, v11
    v_and_b32 v24, 0xffff0000, v24
    v_and_b32 v25, 0xffff0000, v25
    v_and_b32 v26, 0xffff0000, v26
    v_and_b32 v27, 0xffff0000, v27
    v_mul_f32 v20, s12, v24
    v_fma_f32 v21, v24, s12, -v20
    v_fma_f32 v21, v24, s13, v21
    v_exp_f32 v20, v20
    v_mul_f32 v21, s14, v21
    v_fma_f32 v20, v20, v21, v20
    v_cvt_pk_bf16_f32 v20, v20, v20
    v_and_b32 v24, 0xffff0000, v20
    v_mul_f32 v24, -v24, v12
    v_mul_f32 v25, v25, v12
    v_mul_f32 v60, s12, v24
    v_mul_f32 v61, 0.15915494, v25
    v_mul_f32 v64, s72, v24
    v_mul_f32 v65, s74, v25
    v_exp_f32 v60, v60
    v_fract_f32 v61, v61
    v_exp_f32 v64, v64
    v_fract_f32 v65, v65
    v_cos_f32 v62, v61
    v_sin_f32 v63, v61
    v_cos_f32 v66, v65
    v_sin_f32 v67, v65
    v_mul_f32 v26, s73, v26
    v_mul_f32 v27, s73, v27
    v_pk_mul_f32 v[28:29], v[60:61], v[62:63] op_sel:[0,0] op_sel_hi:[0,1]
    v_pk_mul_f32 v[38:39], v[64:65], v[66:67] op_sel:[0,0] op_sel_hi:[0,1]
    v_pk_mul_f32 v[30:31], v[28:29], v[28:29] op_sel:[0,0] op_sel_hi:[1,0]
    v_pk_mul_f32 v[40:41], v[38:39], v[38:39] op_sel:[0,0] op_sel_hi:[1,0]
    v_pk_fma_f32 v[30:31], v[28:29], v[28:29], v[30:31] op_sel:[1,1,0] op_sel_hi:[0,1,1] neg_lo:[1,0,0]
    v_pk_fma_f32 v[40:41], v[38:39], v[38:39], v[40:41] op_sel:[1,1,0] op_sel_hi:[0,1,1] neg_lo:[1,0,0]
    v_pk_mul_f32 v[32:33], v[30:31], v[30:31] op_sel:[0,0] op_sel_hi:[1,0]
    v_pk_mul_f32 v[42:43], v[40:41], v[40:41] op_sel:[0,0] op_sel_hi:[1,0]
    v_pk_fma_f32 v[32:33], v[30:31], v[30:31], v[32:33] op_sel:[1,1,0] op_sel_hi:[0,1,1] neg_lo:[1,0,0]
    v_pk_fma_f32 v[42:43], v[40:41], v[40:41], v[42:43] op_sel:[1,1,0] op_sel_hi:[0,1,1] neg_lo:[1,0,0]
    v_pk_mul_f32 v[34:35], v[32:33], v[32:33] op_sel:[0,0] op_sel_hi:[1,0]
    v_pk_mul_f32 v[44:45], v[42:43], v[42:43] op_sel:[0,0] op_sel_hi:[1,0]
    v_pk_fma_f32 v[34:35], v[32:33], v[32:33], v[34:35] op_sel:[1,1,0] op_sel_hi:[0,1,1] neg_lo:[1,0,0]
    v_pk_fma_f32 v[44:45], v[42:43], v[42:43], v[44:45] op_sel:[1,1,0] op_sel_hi:[0,1,1] neg_lo:[1,0,0]
    v_pk_mul_f32 v[36:37], v[34:35], v[34:35] op_sel:[0,0] op_sel_hi:[1,0]
    v_pk_fma_f32 v[36:37], v[34:35], v[34:35], v[36:37] op_sel:[1,1,0] op_sel_hi:[0,1,1] neg_lo:[1,0,0]
    v_mov_b32 v84, 0x3c00
    v_cvt_pk_f16_f32 v85, v34, v35
    v_cvt_pk_f16_f32 v86, v36, v37
    v_cvt_pk_f16_f32 v88, v38, v39
    v_cvt_pk_f16_f32 v92, v40, v41
    v_cvt_pk_f16_f32 v100, v42, v43
    v_pk_mul_f16 v87, v85, v86 op_sel:[0,0] op_sel_hi:[1,0]
    v_pk_mul_f16 v89, v85, v88 op_sel:[0,0] op_sel_hi:[1,0]
    v_pk_mul_f16 v90, v86, v88 op_sel:[0,0] op_sel_hi:[1,0]
    v_pk_fma_f16 v87, v85, v86, v87 op_sel:[1,1,0] op_sel_hi:[0,1,1] neg_lo:[1,0,0]
    v_pk_fma_f16 v89, v85, v88, v89 op_sel:[1,1,0] op_sel_hi:[0,1,1] neg_lo:[1,0,0]
    v_pk_fma_f16 v90, v86, v88, v90 op_sel:[1,1,0] op_sel_hi:[0,1,1] neg_lo:[1,0,0]
    v_pk_mul_f32 v[46:47], v[26:27], v[44:45] op_sel:[0,0] op_sel_hi:[1,0]
    v_pk_fma_f32 v[46:47], v[26:27], v[44:45], v[46:47] op_sel:[1,1,0] op_sel_hi:[0,1,1] neg_lo:[1,0,0]
    ds_write_addtid_b32 v84 offset:27520
    ds_write_addtid_b32 v85 offset:27792
    ds_write_addtid_b32 v86 offset:28064
    ds_write_addtid_b32 v88 offset:28608
    ds_write_addtid_b32 v92 offset:29696
    ds_write_addtid_b32 v100 offset:31872
    v_pk_mul_f16 v91, v87, v88 op_sel:[0,0] op_sel_hi:[1,0]
    v_pk_mul_f16 v93, v85, v92 op_sel:[0,0] op_sel_hi:[1,0]
    v_pk_mul_f16 v94, v86, v92 op_sel:[0,0] op_sel_hi:[1,0]
    v_pk_fma_f16 v91, v87, v88, v91 op_sel:[1,1,0] op_sel_hi:[0,1,1] neg_lo:[1,0,0]
    v_pk_fma_f16 v93, v85, v92, v93 op_sel:[1,1,0] op_sel_hi:[0,1,1] neg_lo:[1,0,0]
    v_pk_fma_f16 v94, v86, v92, v94 op_sel:[1,1,0] op_sel_hi:[0,1,1] neg_lo:[1,0,0]
    v_pk_mul_f32 v[48:49], v[46:47], v[44:45] op_sel:[0,0] op_sel_hi:[1,0]
    v_pk_fma_f32 v[48:49], v[46:47], v[44:45], v[48:49] op_sel:[1,1,0] op_sel_hi:[0,1,1] neg_lo:[1,0,0]
    v_pk_mul_f16 v95, v87, v92 op_sel:[0,0] op_sel_hi:[1,0]
    v_pk_mul_f16 v96, v88, v92 op_sel:[0,0] op_sel_hi:[1,0]
    v_pk_mul_f16 v97, v89, v92 op_sel:[0,0] op_sel_hi:[1,0]
    v_pk_fma_f16 v95, v87, v92, v95 op_sel:[1,1,0] op_sel_hi:[0,1,1] neg_lo:[1,0,0]
    v_pk_fma_f16 v96, v88, v92, v96 op_sel:[1,1,0] op_sel_hi:[0,1,1] neg_lo:[1,0,0]
    v_pk_fma_f16 v97, v89, v92, v97 op_sel:[1,1,0] op_sel_hi:[0,1,1] neg_lo:[1,0,0]
    v_pk_mul_f32 v[50:51], v[48:49], v[44:45] op_sel:[0,0] op_sel_hi:[1,0]
    v_pk_fma_f32 v[50:51], v[48:49], v[44:45], v[50:51] op_sel:[1,1,0] op_sel_hi:[0,1,1] neg_lo:[1,0,0]
    ds_write_addtid_b32 v87 offset:28336
    ds_write_addtid_b32 v89 offset:28880
    ds_write_addtid_b32 v90 offset:29152
    ds_write_addtid_b32 v91 offset:29424
    ds_write_addtid_b32 v93 offset:29968
    ds_write_addtid_b32 v94 offset:30240
    v_pk_mul_f16 v98, v90, v92 op_sel:[0,0] op_sel_hi:[1,0]
    v_pk_mul_f16 v99, v91, v92 op_sel:[0,0] op_sel_hi:[1,0]
    v_pk_mul_f16 v101, v85, v100 op_sel:[0,0] op_sel_hi:[1,0]
    v_pk_fma_f16 v98, v90, v92, v98 op_sel:[1,1,0] op_sel_hi:[0,1,1] neg_lo:[1,0,0]
    v_pk_fma_f16 v99, v91, v92, v99 op_sel:[1,1,0] op_sel_hi:[0,1,1] neg_lo:[1,0,0]
    v_pk_fma_f16 v101, v85, v100, v101 op_sel:[1,1,0] op_sel_hi:[0,1,1] neg_lo:[1,0,0]
    v_pk_mul_f32 v[52:53], v[50:51], v[44:45] op_sel:[0,0] op_sel_hi:[1,0]
    v_pk_fma_f32 v[52:53], v[50:51], v[44:45], v[52:53] op_sel:[1,1,0] op_sel_hi:[0,1,1] neg_lo:[1,0,0]
    v_pk_mul_f16 v102, v86, v100 op_sel:[0,0] op_sel_hi:[1,0]
    v_pk_mul_f16 v103, v87, v100 op_sel:[0,0] op_sel_hi:[1,0]
    v_pk_mul_f16 v104, v88, v100 op_sel:[0,0] op_sel_hi:[1,0]
    v_pk_fma_f16 v102, v86, v100, v102 op_sel:[1,1,0] op_sel_hi:[0,1,1] neg_lo:[1,0,0]
    v_pk_fma_f16 v103, v87, v100, v103 op_sel:[1,1,0] op_sel_hi:[0,1,1] neg_lo:[1,0,0]
    v_pk_fma_f16 v104, v88, v100, v104 op_sel:[1,1,0] op_sel_hi:[0,1,1] neg_lo:[1,0,0]
    v_pk_mul_f32 v[54:55], v[52:53], v[44:45] op_sel:[0,0] op_sel_hi:[1,0]
    v_pk_fma_f32 v[54:55], v[52:53], v[44:45], v[54:55] op_sel:[1,1,0] op_sel_hi:[0,1,1] neg_lo:[1,0,0]
    ds_write_addtid_b32 v95 offset:30512
    ds_write_addtid_b32 v96 offset:30784
    ds_write_addtid_b32 v97 offset:31056
    ds_write_addtid_b32 v98 offset:31328
    ds_write_addtid_b32 v99 offset:31600
    ds_write_addtid_b32 v101 offset:32144
    v_pk_mul_f16 v105, v89, v100 op_sel:[0,0] op_sel_hi:[1,0]
    v_pk_mul_f16 v106, v90, v100 op_sel:[0,0] op_sel_hi:[1,0]
    v_pk_mul_f16 v107, v91, v100 op_sel:[0,0] op_sel_hi:[1,0]
    v_pk_fma_f16 v105, v89, v100, v105 op_sel:[1,1,0] op_sel_hi:[0,1,1] neg_lo:[1,0,0]
    v_pk_fma_f16 v106, v90, v100, v106 op_sel:[1,1,0] op_sel_hi:[0,1,1] neg_lo:[1,0,0]
    v_pk_fma_f16 v107, v91, v100, v107 op_sel:[1,1,0] op_sel_hi:[0,1,1] neg_lo:[1,0,0]
    v_pk_mul_f32 v[56:57], v[54:55], v[44:45] op_sel:[0,0] op_sel_hi:[1,0]
    v_pk_fma_f32 v[56:57], v[54:55], v[44:45], v[56:57] op_sel:[1,1,0] op_sel_hi:[0,1,1] neg_lo:[1,0,0]
    v_pk_mul_f16 v108, v92, v100 op_sel:[0,0] op_sel_hi:[1,0]
    v_pk_mul_f16 v109, v93, v100 op_sel:[0,0] op_sel_hi:[1,0]
    v_pk_mul_f16 v110, v94, v100 op_sel:[0,0] op_sel_hi:[1,0]
    v_pk_fma_f16 v108, v92, v100, v108 op_sel:[1,1,0] op_sel_hi:[0,1,1] neg_lo:[1,0,0]
    v_pk_fma_f16 v109, v93, v100, v109 op_sel:[1,1,0] op_sel_hi:[0,1,1] neg_lo:[1,0,0]
    v_pk_fma_f16 v110, v94, v100, v110 op_sel:[1,1,0] op_sel_hi:[0,1,1] neg_lo:[1,0,0]
    v_pk_mul_f32 v[58:59], v[56:57], v[44:45] op_sel:[0,0] op_sel_hi:[1,0]
    v_pk_fma_f32 v[58:59], v[56:57], v[44:45], v[58:59] op_sel:[1,1,0] op_sel_hi:[0,1,1] neg_lo:[1,0,0]
    ds_write_addtid_b32 v102 offset:32416
    ds_write_addtid_b32 v103 offset:32688
    ds_write_addtid_b32 v104 offset:32960
    ds_write_addtid_b32 v105 offset:33232
    ds_write_addtid_b32 v106 offset:33504
    ds_write_addtid_b32 v107 offset:33776
    v_pk_mul_f16 v111, v95, v100 op_sel:[0,0] op_sel_hi:[1,0]
    v_pk_mul_f16 v112, v96, v100 op_sel:[0,0] op_sel_hi:[1,0]
    v_pk_mul_f16 v113, v97, v100 op_sel:[0,0] op_sel_hi:[1,0]
    v_pk_fma_f16 v111, v95, v100, v111 op_sel:[1,1,0] op_sel_hi:[0,1,1] neg_lo:[1,0,0]
    v_pk_fma_f16 v112, v96, v100, v112 op_sel:[1,1,0] op_sel_hi:[0,1,1] neg_lo:[1,0,0]
    v_pk_fma_f16 v113, v97, v100, v113 op_sel:[1,1,0] op_sel_hi:[0,1,1] neg_lo:[1,0,0]
    v_pk_mul_f16 v114, v98, v100 op_sel:[0,0] op_sel_hi:[1,0]
    v_pk_mul_f16 v115, v99, v100 op_sel:[0,0] op_sel_hi:[1,0]
    v_pk_fma_f16 v114, v98, v100, v114 op_sel:[1,1,0] op_sel_hi:[0,1,1] neg_lo:[1,0,0]
    v_pk_fma_f16 v115, v99, v100, v115 op_sel:[1,1,0] op_sel_hi:[0,1,1] neg_lo:[1,0,0]
    ds_write_addtid_b32 v108 offset:34048
    ds_write_addtid_b32 v109 offset:34320
    ds_write_addtid_b32 v110 offset:34592
    ds_write_addtid_b32 v111 offset:34864
    ds_write_addtid_b32 v112 offset:35136
    ds_write_addtid_b32 v113 offset:35408
    v_cvt_pk_f16_f32 v68, v28, v29
    v_cvt_pk_f16_f32 v69, v30, v31
    v_cvt_pk_f16_f32 v70, v32, v33
    ds_write_addtid_b32 v114 offset:35680
    ds_write_addtid_b32 v115 offset:35952
    v_mov_b32 v71, v85
    ds_read_b128 v[120:123], v15 offset:0
    ds_read_b128 v[124:127], v15 offset:32
    ds_read_b128 v[128:131], v15 offset:64
    ds_read_b128 v[132:135], v15 offset:96
    ds_read_b128 v[136:139], v15 offset:128
    ds_read_b128 v[140:143], v15 offset:160
    ds_read_b128 v[144:147], v15 offset:192
    ds_read_b128 v[148:151], v15 offset:224
    s_cmp_lt_u32 s3, 4
    s_cselect_b32 s6, s7, 0
    s_cmp_lg_u32 s6, 0
    s_cbranch_scc1 L_A_u2
    s_cmp_eq_u32 s70, 2
    s_cbranch_scc1 L_A_u1
    buffer_load_dwordx3 v[200:202], v3, s[56:59], s11 offen offset:0
    buffer_load_dwordx3 v[204:206], v3, s[56:59], s11 offen offset:1152
    buffer_load_dwordx3 v[208:210], v3, s[56:59], s11 offen offset:2304
    buffer_load_dwordx3 v[212:214], v3, s[56:59], s11 offen offset:3456
    s_branch L_A_u2
L_A_u1:
    buffer_load_dwordx2 v[200:201], v3, s[56:59], s11 offen offset:0
    buffer_load_dwordx2 v[204:205], v3, s[56:59], s11 offen offset:1152
    buffer_load_dwordx2 v[208:209], v3, s[56:59], s11 offen offset:2304
    buffer_load_dwordx2 v[212:213], v3, s[56:59], s11 offen offset:3456
L_A_u2:
    v_cvt_pk_f16_f32 v84, v26, -v27
    v_cvt_pk_f16_f32 v93, v46, -v47
    v_cvt_pk_f16_f32 v98, v48, -v49
    v_cvt_pk_f16_f32 v101, v50, -v51
    v_cvt_pk_f16_f32 v104, v52, -v53
    v_cvt_pk_f16_f32 v106, v54, -v55
    v_cvt_pk_f16_f32 v108, v56, -v57
    v_cvt_pk_f16_f32 v110, v58, -v59
    v_pk_mul_f16 v85, v84, v68 op_sel:[0,0] op_sel_hi:[1,0]
    v_pk_mul_f16 v86, v84, v69 op_sel:[0,0] op_sel_hi:[1,0]
    v_pk_mul_f16 v88, v84, v70 op_sel:[0,0] op_sel_hi:[1,0]
    v_pk_fma_f16 v85, v84, v68, v85 op_sel:[1,1,0] op_sel_hi:[0,1,1] neg_hi:[1,0,0]
    v_pk_fma_f16 v86, v84, v69, v86 op_sel:[1,1,0] op_sel_hi:[0,1,1] neg_hi:[1,0,0]
    v_pk_fma_f16 v88, v84, v70, v88 op_sel:[1,1,0] op_sel_hi:[0,1,1] neg_hi:[1,0,0]
    ds_write_addtid_b32 v84 offset:27520
    ds_write_addtid_b32 v93 offset:29968
    ds_write_addtid_b32 v98 offset:31328
    ds_write_addtid_b32 v101 offset:32144
    ds_write_addtid_b32 v104 offset:32960
    ds_write_addtid_b32 v106 offset:33504
    ds_write_addtid_b32 v108 offset:34048
    ds_write_addtid_b32 v110 offset:34592
    v_pk_mul_f16 v92, v84, v71 op_sel:[0,0] op_sel_hi:[1,0]
    v_pk_mul_f16 v94, v93, v69 op_sel:[0,0] op_sel_hi:[1,0]
    v_pk_mul_f16 v95, v93, v70 op_sel:[0,0] op_sel_hi:[1,0]
    v_pk_fma_f16 v92, v84, v71, v92 op_sel:[1,1,0] op_sel_hi:[0,1,1] neg_hi:[1,0,0]
    v_pk_fma_f16 v94, v93, v69, v94 op_sel:[1,1,0] op_sel_hi:[0,1,1] neg_hi:[1,0,0]
    v_pk_fma_f16 v95, v93, v70, v95 op_sel:[1,1,0] op_sel_hi:[0,1,1] neg_hi:[1,0,0]
    v_pk_mul_f16 v97, v93, v71 op_sel:[0,0] op_sel_hi:[1,0]
    v_pk_mul_f16 v99, v98, v70 op_sel:[0,0] op_sel_hi:[1,0]
    v_pk_mul_f16 v100, v98, v71 op_sel:[0,0] op_sel_hi:[1,0]
    v_pk_fma_f16 v97, v93, v71, v97 op_sel:[1,1,0] op_sel_hi:[0,1,1] neg_hi:[1,0,0]
    v_pk_fma_f16 v99, v98, v70, v99 op_sel:[1,1,0] op_sel_hi:[0,1,1] neg_hi:[1,0,0]
    v_pk_fma_f16 v100, v98, v71, v100 op_sel:[1,1,0] op_sel_hi:[0,1,1] neg_hi:[1,0,0]
    ds_write_addtid_b32 v85 offset:27792
    ds_write_addtid_b32 v86 offset:28064
    ds_write_addtid_b32 v88 offset:28608
    ds_write_addtid_b32 v92 offset:29696
    ds_write_addtid_b32 v94 offset:30240
    ds_write_addtid_b32 v95 offset:30512
    v_pk_mul_f16 v102, v101, v70 op_sel:[0,0] op_sel_hi:[1,0]
    v_pk_mul_f16 v103, v101, v71 op_sel:[0,0] op_sel_hi:[1,0]
    v_pk_mul_f16 v105, v104, v71 op_sel:[0,0] op_sel_hi:[1,0]
    v_pk_fma_f16 v102, v101, v70, v102 op_sel:[1,1,0] op_sel_hi:[0,1,1] neg_hi:[1,0,0]
    v_pk_fma_f16 v103, v101, v71, v103 op_sel:[1,1,0] op_sel_hi:[0,1,1] neg_hi:[1,0,0]
    v_pk_fma_f16 v105, v104, v71, v105 op_sel:[1,1,0] op_sel_hi:[0,1,1] neg_hi:[1,0,0]
    v_pk_mul_f16 v107, v106, v71 op_sel:[0,0] op_sel_hi:[1,0]
    v_pk_mul_f16 v109, v108, v71 op_sel:[0,0] op_sel_hi:[1,0]
    v_pk_mul_f16 v111, v110, v71 op_sel:[0,0] op_sel_hi:[1,0]
    v_pk_fma_f16 v107, v106, v71, v107 op_sel:[1,1,0] op_sel_hi:[0,1,1] neg_hi:[1,0,0]
    v_pk_fma_f16 v109, v108, v71, v109 op_sel:[1,1,0] op_sel_hi:[0,1,1] neg_hi:[1,0,0]
    v_pk_fma_f16 v111, v110, v71, v111 op_sel:[1,1,0] op_sel_hi:[0,1,1] neg_hi:[1,0,0]
    ds_write_addtid_b32 v97 offset:31056
    ds_write_addtid_b32 v99 offset:31600
    ds_write_addtid_b32 v100 offset:31872
    ds_write_addtid_b32 v102 offset:32416
    ds_write_addtid_b32 v103 offset:32688
    ds_write_addtid_b32 v105 offset:33232
    v_pk_mul_f16 v87, v85, v69 op_sel:[0,0] op_sel_hi:[1,0]
    v_pk_mul_f16 v89, v85, v70 op_sel:[0,0] op_sel_hi:[1,0]
    v_pk_mul_f16 v90, v86, v70 op_sel:[0,0] op_sel_hi:[1,0]
    v_pk_fma_f16 v87, v85, v69, v87 op_sel:[1,1,0] op_sel_hi:[0,1,1] neg_hi:[1,0,0]
    v_pk_fma_f16 v89, v85, v70, v89 op_sel:[1,1,0] op_sel_hi:[0,1,1] neg_hi:[1,0,0]
    v_pk_fma_f16 v90, v86, v70, v90 op_sel:[1,1,0] op_sel_hi:[0,1,1] neg_hi:[1,0,0]
    v_pk_mul_f16 v96, v94, v70 op_sel:[0,0] op_sel_hi:[1,0]
    v_pk_mul_f16 v91, v87, v70 op_sel:[0,0] op_sel_hi:[1,0]
    v_pk_fma_f16 v96, v94, v70, v96 op_sel:[1,1,0] op_sel_hi:[0,1,1] neg_hi:[1,0,0]
    v_pk_fma_f16 v91, v87, v70, v91 op_sel:[1,1,0] op_sel_hi:[0,1,1] neg_hi:[1,0,0]
    ds_write_addtid_b32 v107 offset:33776
    ds_write_addtid_b32 v109 offset:34320
    ds_write_addtid_b32 v111 offset:34864
    ds_write_addtid_b32 v87 offset:28336
    ds_write_addtid_b32 v89 offset:28880
    ds_write_addtid_b32 v90 offset:29152
    ds_write_addtid_b32 v96 offset:30784
    ds_write_addtid_b32 v91 offset:29424
    ds_read_b128 v[152:155], v16 offset:0
    ds_read_b128 v[156:159], v16 offset:32
    ds_read_b128 v[160:163], v16 offset:64
    ds_read_b128 v[164:167], v16 offset:96
    ds_read_b128 v[168:171], v16 offset:128
    ds_read_b128 v[172:175], v16 offset:160
    ds_read_b128 v[176:179], v16 offset:192
    ds_read_b128 v[180:183], v16 offset:224
    s_waitcnt lgkmcnt(7)
    v_mfma_f32_32x32x16_f16 v[220:235], v[152:155], v[120:123], v[220:235]
    s_waitcnt lgkmcnt(6)
    v_mfma_f32_32x32x16_f16 v[220:235], v[156:159], v[124:127], v[220:235]
    s_waitcnt lgkmcnt(5)
    v_mfma_f32_32x32x16_f16 v[220:235], v[160:163], v[128:131], v[220:235]
    s_waitcnt lgkmcnt(4)
    v_mfma_f32_32x32x16_f16 v[220:235], v[164:167], v[132:135], v[220:235]
    s_waitcnt lgkmcnt(3)
    v_mfma_f32_32x32x16_f16 v[220:235], v[168:171], v[136:139], v[220:235]
    s_waitcnt lgkmcnt(2)
    v_mfma_f32_32x32x16_f16 v[220:235], v[172:175], v[140:143], v[220:235]
    s_waitcnt lgkmcnt(1)
    v_mfma_f32_32x32x16_f16 v[220:235], v[176:179], v[144:147], v[220:235]
    s_waitcnt lgkmcnt(0)
    v_mfma_f32_32x32x16_f16 v[220:235], v[180:183], v[148:151], v[220:235]
    s_add_u32 s7, s7, 1
    s_cmp_lt_u32 s7, s77
    s_cbranch_scc1 L_A_half
    v_lshl_add_u32 v21, v0, 4, s15
    s_cmp_ge_u32 s3, 6
    s_cbranch_scc1 L_A_give
    s_cmp_lt_u32 s3, 4
    s_cbranch_scc1 L_A_exp
L_A_w0:
    ds_read_b32 v23, v19 offset:0
    s_waitcnt lgkmcnt(0)
    v_cmp_eq_u32 vcc, 0, v23
    s_cbranch_vccnz L_A_w0
    ds_read_b128 v[40:43], v21 offset:17536
    ds_read_b128 v[44:47], v21 offset:18560
    ds_read_b128 v[48:51], v21 offset:19584
    ds_read_b128 v[52:55], v21 offset:20608
    s_waitcnt lgkmcnt(0)
    v_pk_add_f32 v[220:221], v[220:221], v[40:41]
    v_pk_add_f32 v[222:223], v[222:223], v[42:43]
    v_pk_add_f32 v[224:225], v[224:225], v[44:45]
    v_pk_add_f32 v[226:227], v[226:227], v[46:47]
    v_pk_add_f32 v[228:229], v[228:229], v[48:49]
    v_pk_add_f32 v[230:231], v[230:231], v[50:51]
    v_pk_add_f32 v[232:233], v[232:233], v[52:53]
    v_pk_add_f32 v[234:235], v[234:235], v[54:55]
L_A_exp:
    s_nop 3
    v_pk_mul_f32 v[220:221], v[16:17], v[220:221] op_sel:[1,0] op_sel_hi:[1,1]
    v_pk_mul_f32 v[222:223], v[16:17], v[222:223] op_sel:[1,0] op_sel_hi:[1,1]
    v_pk_mul_f32 v[224:225], v[16:17], v[224:225] op_sel:[1,0] op_sel_hi:[1,1]
    v_pk_mul_f32 v[226:227], v[16:17], v[226:227] op_sel:[1,0] op_sel_hi:[1,1]
    v_pk_mul_f32 v[228:229], v[16:17], v[228:229] op_sel:[1,0] op_sel_hi:[1,1]
    v_pk_mul_f32 v[230:231], v[16:17], v[230:231] op_sel:[1,0] op_sel_hi:[1,1]
    v_pk_mul_f32 v[232:233], v[16:17], v[232:233] op_sel:[1,0] op_sel_hi:[1,1]
    v_pk_mul_f32 v[234:235], v[16:17], v[234:235] op_sel:[1,0] op_sel_hi:[1,1]
    v_cmp_eq_u32 vcc, 1, v237
    s_nop 1
    v_cndmask_b32 v40, v232, v233, vcc
    v_cndmask_b32 v41, v234, v235, vcc
    v_cvt_pk_bf16_f32 v48, v220, v221
    v_cvt_pk_bf16_f32 v49, v222, v223
    v_cvt_pk_bf16_f32 v50, v224, v225
    v_cvt_pk_bf16_f32 v51, v226, v227
    v_cvt_pk_bf16_f32 v52, v221, v222
    v_cvt_pk_bf16_f32 v53, v223, v224
    v_cvt_pk_bf16_f32 v54, v225, v226
    v_cvt_pk_bf16_f32 v55, v227, v228
    ds_write_b128 v21, v[48:51] offset:32
    v_cvt_pk_bf16_f32 v56, v229, v229
    v_cvt_pk_bf16_f32 v57, v229, v230
    v_cvt_pk_bf16_f32 v58, v230, v230
    v_cvt_pk_bf16_f32 v59, v231, v231
    ds_write_b128 v21, v[52:55] offset:4192
    v_cvt_pk_bf16_f32 v60, v229, v229
    v_cvt_pk_bf16_f32 v61, v230, v230
    v_cvt_pk_bf16_f32 v62, v230, v231
    v_cvt_pk_bf16_f32 v63, v231, v231
    ds_write_b128 v21, v[56:59] offset:1056
    v_cvt_pk_bf16_f32 v64, v232, v232
    v_cvt_pk_bf16_f32 v65, v232, v232
    v_cvt_pk_bf16_f32 v66, v40, v233
    v_cvt_pk_bf16_f32 v67, v233, v233
    ds_write_b128 v21, v[60:63] offset:5216
    v_cvt_pk_bf16_f32 v68, v232, v232
    v_cvt_pk_bf16_f32 v69, v232, v40
    v_cvt_pk_bf16_f32 v70, v233, v233
    v_cvt_pk_bf16_f32 v71, v233, v233
    ds_write_b128 v21, v[64:67] offset:2080
    v_cvt_pk_bf16_f32 v72, v234, v234
    v_cvt_pk_bf16_f32 v73, v234, v234
    v_cvt_pk_bf16_f32 v74, v41, v235
    v_cvt_pk_bf16_f32 v75, v235, v235
    ds_write_b128 v21, v[68:71] offset:6240
    v_cvt_pk_bf16_f32 v76, v234, v234
    v_cvt_pk_bf16_f32 v77, v234, v41
    v_cvt_pk_bf16_f32 v78, v235, v235
    v_cvt_pk_bf16_f32 v79, v235, v235
    ds_write_b128 v21, v[72:75] offset:3104
    v_lshlrev_b32 v219, 16, v48
    ds_write_b128 v21, v[76:79] offset:7264
    s_mov_b64 exec, 1
    ds_write_b128 v21, v[216:219] offset:4176
    v_mov_b32 v219, 0
    ds_write_b128 v21, v[216:219]
    ds_write_b128 v21, v[216:219] offset:16
    ds_write_b128 v21, v[216:219] offset:4160
    s_mov_b64 exec, -1
    s_branch L_A_tr
L_A_give:
    s_nop 5
    ds_write_b128 v21, v[220:223] offset:0
    ds_write_b128 v21, v[224:227] offset:1024
    ds_write_b128 v21, v[228:231] offset:2048
    ds_write_b128 v21, v[232:235] offset:3072
    v_mov_b32 v23, 1
    s_mov_b64 exec, 1
    ds_add_u32 v19, v23 offset:0
    s_mov_b64 exec, -1
L_A_give2:
    v_mov_b32 v13, 0
    v_min_u32 v20, 49, v0
    v_lshlrev_b32 v20, 7, v20
    s_cmp_eq_u32 s3, 6
    s_cselect_b32 s6, 6, 3
    s_mul_i32 s6, s6, 6400
    s_sub_u32 s71, s71, s6
    s_mov_b32 s60, s40
    s_mov_b32 s61, s41
    s_mov_b32 s62, 0xa2000
    s_mov_b32 s63, 0x20000
    s_add_u32 s6, s71, 0
    buffer_load_dword v251, v20, s[60:63], s6 offen
    s_add_u32 s6, s71, 6400
    buffer_load_dword v251, v20, s[60:63], s6 offen
    s_add_u32 s6, s71, 12800
    buffer_load_dword v251, v20, s[60:63], s6 offen
    s_add_u32 s6, s71, 19200
    buffer_load_dword v251, v20, s[60:63], s6 offen
    s_mov_b32 s60, s42
    s_mov_b32 s61, s43
    s_mov_b32 s62, 0xa2000
    s_mov_b32 s63, 0x20000
    s_add_u32 s6, s71, 0
    buffer_load_dword v251, v20, s[60:63], s6 offen
    s_add_u32 s6, s71, 6400
    buffer_load_dword v251, v20, s[60:63], s6 offen
    s_add_u32 s6, s71, 12800
    buffer_load_dword v251, v20, s[60:63], s6 offen
    s_add_u32 s6, s71, 19200
    buffer_load_dword v251, v20, s[60:63], s6 offen
    s_waitcnt vmcnt(8)
    s_branch L_A_tr2
L_A_tr:
    s_waitcnt vmcnt(0)
L_A_tr2:
    v_and_b32 v22, 1, v238
    v_lshlrev_b32 v22, 4, v22
    v_lshlrev_b32 v22, v22, v13
    v_ashrrev_i32 v18, 1, v238
    v_cmp_eq_u32 vcc, 0, v18
    s_nop 1
    v_cndmask_b32 v192, 0, v22, vcc
    v_cmp_eq_u32 vcc, 1, v18
    s_nop 1
    v_cndmask_b32 v193, 0, v22, vcc
    v_cmp_eq_u32 vcc, 2, v18
    s_nop 1
    v_cndmask_b32 v194, 0, v22, vcc
    v_cmp_eq_u32 vcc, 3, v18
    s_nop 1
    v_cndmask_b32 v195, 0, v22, vcc
    v_perm_b32 v24, v208, v212, s68
    v_perm_b32 v25, v200, v204, s68
    v_perm_b32 v26, v208, v212, s69
    v_perm_b32 v27, v200, v204, s69
    v_perm_b32 v28, v209, v213, s68
    v_perm_b32 v29, v201, v205, s68
    v_perm_b32 v30, v209, v213, s69
    v_perm_b32 v31, v201, v205, s69
    v_perm_b32 v32, v210, v214, s68
    v_perm_b32 v33, v202, v206, s68
    v_perm_b32 v34, v210, v214, s69
    v_perm_b32 v35, v202, v206, s69
    ds_write_b64 v236, v[24:25] offset:0
    ds_write_b64 v236, v[26:27] offset:4576
    ds_write_b64 v236, v[28:29] offset:9152
    ds_write_b64 v236, v[30:31] offset:13728
    ds_write_b64 v236, v[32:33] offset:18304
    ds_write_b64 v236, v[34:35] offset:22880
    s_setprio 0
    v_mov_b32 v228, v240
    v_mov_b32 v229, v241
    v_mov_b32 v230, v242
    v_mov_b32 v231, v243
    v_mov_b32 v232, v244
    v_mov_b32 v196, 0
    v_mov_b32 v197, 0
    v_mov_b32 v198, 0
    v_mov_b32 v199, 0
    v_mov_b32 v200, 0
    v_mov_b32 v201, 0
    v_mov_b32 v202, 0
    v_mov_b32 v203, 0
    v_mov_b32 v204, 0
    v_mov_b32 v205, 0
    v_mov_b32 v206, 0
    v_mov_b32 v207, 0
    v_mov_b32 v208, 0
    v_mov_b32 v209, 0
    v_mov_b32 v210, 0
    v_mov_b32 v211, 0
    v_subrev_u32 v234, s15, v246
    s_lshl_b32 s6, s3, 13
    s_add_u32 s6, s6, 101760
    v_add_u32 v234, s6, v234
    s_cmp_eq_u32 s70, 2
    s_cselect_b32 s9, 2, 3
    s_lshl_b32 s71, s9, 1
    s_lshl_b32 s6, s3, 2
    s_mov_b32 s7, 0x66006644
    s_lshr_b32 s7, s7, s6
    s_and_b32 s72, s7, 15
    s_mov_b32 s7, 0xda007420
    s_lshr_b32 s7, s7, s6
    s_and_b32 s7, s7, 15
    s_lshl_b32 s7, s7, 1
    v_lshrrev_b32 v22, 1, v0
    s_lshl_b32 s6, s9, 13
    v_mul_u32_u24 v235, s6, v237
    v_lshl_add_u32 v235, v22, 2, v235
    s_lshl_b32 s6, s7, 7
    s_add_u32 s6, s6, 101760
    v_add_u32 v235, s6, v235
    s_mul_i32 s73, s7, 147456
    s_add_u32 s73, s73, s8
    s_mul_i32 s7, s9, 8768
    v_mul_u32_u24 v247, s7, v237
    v_lshl_add_u32 v247, v22, 2, v247
    s_lshl_b32 s6, s3, 9
    s_add_u32 s6, s6, 27520
    v_add_u32 v247, s6, v247
    v_mul_u32_u24 v248, 4608, v22
    s_lshl_b32 s6, s9, 2
    v_mul_u32_u24 v23, s6, v237
    v_add_u32 v248, v248, v23
    s_mul_i32 s6, s3, 589824
    s_add_u32 s8, s8, s6
    s_add_u32 s8, s8, 4718592
    s_lshl_b32 s6, s3, 2
    s_mov_b32 s7, 0x33224433
    s_lshr_b32 s7, s7, s6
    s_and_b32 s74, s7, 15
    s_mov_b32 s75, 0
    v_mov_b32 v233, 27456
    s_cmp_ge_u32 s3, 6
    s_cselect_b32 s54, 34880, 64
    s_cselect_b32 s55, 18560, 0
    s_sub_u32 s55, s55, 64
    s_lshr_b32 s79, s3, 2
    s_waitcnt lgkmcnt(0)
    s_barrier
    s_cmp_ge_u32 s3, 6
    s_cbranch_scc1 L_A_hlp
    s_cmp_ge_u32 s3, s71
    s_cbranch_scc1 L_A1_end
    s_setprio 2
    ds_read_b128 v[56:59], v244 offset:0
    ds_read_b128 v[60:63], v244 offset:512
    ds_read_b128 v[64:67], v244 offset:1024
    ds_read_b128 v[68:71], v244 offset:1536
    ds_read2_b32 v[24:25], v240 offset0:0 offset1:1
    ds_read2_b32 v[26:27], v240 offset0:2 offset1:3
    ds_read2_b32 v[28:29], v240 offset0:128 offset1:129
    ds_read2_b32 v[30:31], v240 offset0:130 offset1:131
    ds_read2_b32 v[32:33], v241 offset0:0 offset1:1
    ds_read2_b32 v[34:35], v241 offset0:2 offset1:3
    ds_read2_b32 v[36:37], v241 offset0:128 offset1:129
    ds_read2_b32 v[38:39], v241 offset0:130 offset1:131
    v_add_u32 v240, 64, v240
    v_add_u32 v241, 64, v241
    v_subrev_u32 v244, 64, v244
    s_mov_b32 s7, 0
L_A0_init:
    s_waitcnt lgkmcnt(0)
    v_mfma_f32_16x16x32_bf16 v[160:163], v[192:195], v[56:59], 0
    v_mfma_f32_16x16x32_bf16 v[164:167], v[192:195], v[60:63], 0
    v_mfma_f32_16x16x32_bf16 v[168:171], v[192:195], v[64:67], 0
    v_mfma_f32_16x16x32_bf16 v[172:175], v[192:195], v[68:71], 0
L_A0_conv:
    v_mfma_f32_16x16x32_bf16 v[160:163], v[24:27], v[56:59], v[160:163]
    ds_read_b128 v[120:123], v244 offset:0
    ds_read2_b32 v[88:89], v240 offset0:0 offset1:1
    v_mfma_f32_16x16x32_bf16 v[164:167], v[24:27], v[60:63], v[164:167]
    ds_read2_b32 v[90:91], v240 offset0:2 offset1:3
    ds_read_b128 v[124:127], v244 offset:512
    v_mfma_f32_16x16x32_bf16 v[164:167], v[28:31], v[56:59], v[164:167]
    ds_read2_b32 v[92:93], v240 offset0:128 offset1:129
    ds_read2_b32 v[94:95], v240 offset0:130 offset1:131
    v_mfma_f32_16x16x32_bf16 v[168:171], v[28:31], v[60:63], v[168:171]
    ds_read_b128 v[128:131], v244 offset:1024
    ds_read2_b32 v[96:97], v241 offset0:0 offset1:1
    v_mfma_f32_16x16x32_bf16 v[168:171], v[24:27], v[64:67], v[168:171]
    ds_read2_b32 v[98:99], v241 offset0:2 offset1:3
    v_mfma_f32_16x16x32_bf16 v[172:175], v[28:31], v[64:67], v[172:175]
    ds_read_b128 v[132:135], v244 offset:1536
    v_mfma_f32_16x16x32_bf16 v[168:171], v[32:35], v[56:59], v[168:171]
    ds_read2_b32 v[100:101], v241 offset0:128 offset1:129
    v_mfma_f32_16x16x32_bf16 v[172:175], v[32:35], v[60:63], v[172:175]
    ds_read2_b32 v[102:103], v241 offset0:130 offset1:131
    v_mfma_f32_16x16x32_bf16 v[172:175], v[24:27], v[68:71], v[172:175]
    v_add_u32 v240, 64, v240
    v_add_u32 v241, 64, v241
    v_subrev_u32 v244, 64, v244
    v_mfma_f32_16x16x32_bf16 v[172:175], v[36:39], v[56:59], v[172:175]
    s_waitcnt lgkmcnt(0)
    v_mfma_f32_16x16x32_bf16 v[160:163], v[88:91], v[120:123], v[160:163]
    ds_read_b128 v[56:59], v244 offset:0
    ds_read2_b32 v[24:25], v240 offset0:0 offset1:1
    v_mfma_f32_16x16x32_bf16 v[164:167], v[88:91], v[124:127], v[164:167]
    ds_read2_b32 v[26:27], v240 offset0:2 offset1:3
    ds_read_b128 v[60:63], v244 offset:512
    v_mfma_f32_16x16x32_bf16 v[164:167], v[92:95], v[120:123], v[164:167]
    ds_read2_b32 v[28:29], v240 offset0:128 offset1:129
    ds_read2_b32 v[30:31], v240 offset0:130 offset1:131
    v_mfma_f32_16x16x32_bf16 v[168:171], v[92:95], v[124:127], v[168:171]
    ds_read_b128 v[64:67], v244 offset:1024
    ds_read2_b32 v[32:33], v241 offset0:0 offset1:1
    v_mfma_f32_16x16x32_bf16 v[168:171], v[88:91], v[128:131], v[168:171]
    ds_read2_b32 v[34:35], v241 offset0:2 offset1:3
    v_mfma_f32_16x16x32_bf16 v[172:175], v[92:95], v[128:131], v[172:175]
    ds_read_b128 v[68:71], v244 offset:1536
    v_mfma_f32_16x16x32_bf16 v[168:171], v[96:99], v[120:123], v[168:171]
    ds_read2_b32 v[36:37], v241 offset0:128 offset1:129
    v_mfma_f32_16x16x32_bf16 v[172:175], v[96:99], v[124:127], v[172:175]
    ds_read2_b32 v[38:39], v241 offset0:130 offset1:131
    v_mfma_f32_16x16x32_bf16 v[172:175], v[88:91], v[132:135], v[172:175]
    v_add_u32 v240, 64, v240
    v_add_u32 v241, 64, v241
    v_subrev_u32 v244, 64, v244
    v_mfma_f32_16x16x32_bf16 v[172:175], v[100:103], v[120:123], v[172:175]
    s_waitcnt lgkmcnt(0)
    s_add_u32 s7, s7, 1
    s_cmp_lt_u32 s7, 4
    s_cbranch_scc1 L_A0_conv
    ds_write_b128 v234, v[160:163] offset:0
    ds_write_b128 v234, v[164:167] offset:1024
    ds_write_b128 v234, v[168:171] offset:2048
    s_nop 0
    ds_write_b128 v234, v[172:175] offset:3072
    v_mov_b32 v23, 1
    s_mov_b64 exec, 1
    ds_add_u32 v233, v23 offset:16
    s_mov_b64 exec, -1
    s_setprio 0
    v_mov_b32 v240, v228
    v_mov_b32 v241, v229
    v_mov_b32 v242, v230
    v_mov_b32 v243, v231
    v_mov_b32 v244, v232
L_A1_go:
    ds_read_b128 v[56:59], v244 offset:0
    ds_read_b128 v[60:63], v244 offset:512
    ds_read_b128 v[64:67], v244 offset:1024
    ds_read_b128 v[68:71], v244 offset:1536
    ds_read_b128 v[72:75], v244 offset:2048
    ds_read_b128 v[76:79], v244 offset:2560
    ds_read_b128 v[80:83], v244 offset:3072
    ds_read_b128 v[84:87], v244 offset:3584
    ds_read2_b32 v[24:25], v240 offset0:0 offset1:1
    ds_read2_b32 v[26:27], v240 offset0:2 offset1:3
    ds_read2_b32 v[28:29], v240 offset0:128 offset1:129
    ds_read2_b32 v[30:31], v240 offset0:130 offset1:131
    ds_read2_b32 v[32:33], v241 offset0:0 offset1:1
    ds_read2_b32 v[34:35], v241 offset0:2 offset1:3
    ds_read2_b32 v[36:37], v241 offset0:128 offset1:129
    ds_read2_b32 v[38:39], v241 offset0:130 offset1:131
    ds_read2_b32 v[40:41], v242 offset0:0 offset1:1
    ds_read2_b32 v[42:43], v242 offset0:2 offset1:3
    ds_read2_b32 v[44:45], v242 offset0:128 offset1:129
    ds_read2_b32 v[46:47], v242 offset0:130 offset1:131
    ds_read2_b32 v[48:49], v243 offset0:0 offset1:1
    ds_read2_b32 v[50:51], v243 offset0:2 offset1:3
    ds_read2_b32 v[52:53], v243 offset0:128 offset1:129
    ds_read2_b32 v[54:55], v243 offset0:130 offset1:131
    v_add_u32 v240, 64, v240
    v_add_u32 v241, 64, v241
    v_add_u32 v242, 64, v242
    v_add_u32 v243, 64, v243
    v_subrev_u32 v244, 64, v244
    s_mov_b32 s7, 0
L_A1_init:
    s_waitcnt lgkmcnt(0)
    v_mfma_f32_16x16x32_bf16 v[160:163], v[192:195], v[72:75], 0
    v_mfma_f32_16x16x32_bf16 v[164:167], v[192:195], v[76:79], 0
    v_mfma_f32_16x16x32_bf16 v[168:171], v[192:195], v[80:83], 0
    v_mfma_f32_16x16x32_bf16 v[172:175], v[192:195], v[84:87], 0
L_A1_conv:
    v_mfma_f32_16x16x32_bf16 v[160:163], v[32:35], v[64:67], v[160:163]
    ds_read_b128 v[120:123], v244 offset:0
    v_mfma_f32_16x16x32_bf16 v[160:163], v[28:31], v[68:71], v[160:163]
    ds_read2_b32 v[88:89], v240 offset0:0 offset1:1
    v_mfma_f32_16x16x32_bf16 v[164:167], v[32:35], v[68:71], v[164:167]
    ds_read2_b32 v[90:91], v240 offset0:2 offset1:3
    v_mfma_f32_16x16x32_bf16 v[160:163], v[36:39], v[60:63], v[160:163]
    ds_read_b128 v[124:127], v244 offset:512
    v_mfma_f32_16x16x32_bf16 v[164:167], v[36:39], v[64:67], v[164:167]
    ds_read2_b32 v[92:93], v240 offset0:128 offset1:129
    s_cmp_eq_u32 s75, 0
    s_cbranch_scc1 L_A_bs0
    s_waitcnt lgkmcnt(5)
    s_cmp_eq_u32 s70, 2
    s_cbranch_scc1 L_A_st1a
    buffer_store_dwordx3 v[212:214], v248, s[64:67], s73 offen sc1
    s_branch L_A_st1b
L_A_st1a:
    buffer_store_dwordx2 v[212:213], v248, s[64:67], s73 offen sc1
L_A_st1b:
    s_add_u32 s73, s73, 147456
    s_sub_u32 s72, s72, 1
    s_min_u32 s75, s72, 1
    ds_read_b32 v212, v235 offset:0
    ds_read_b32 v213, v235 offset:8192
    ds_read_b32 v214, v235 offset:16384
    v_add_u32 v235, 128, v235
L_A_bs0:
    v_mfma_f32_16x16x32_bf16 v[168:171], v[36:39], v[68:71], v[168:171]
    ds_read2_b32 v[94:95], v240 offset0:130 offset1:131
    v_mfma_f32_16x16x32_bf16 v[160:163], v[24:27], v[72:75], v[160:163]
    ds_read_b128 v[128:131], v244 offset:1024
    v_mfma_f32_16x16x32_bf16 v[164:167], v[28:31], v[72:75], v[164:167]
    ds_read2_b32 v[96:97], v241 offset0:0 offset1:1
    v_mfma_f32_16x16x32_bf16 v[168:171], v[32:35], v[72:75], v[168:171]
    ds_read2_b32 v[98:99], v241 offset0:2 offset1:3
    v_mfma_f32_16x16x32_bf16 v[172:175], v[36:39], v[72:75], v[172:175]
    ds_read_b128 v[132:135], v244 offset:1536
    v_mfma_f32_16x16x32_bf16 v[160:163], v[40:43], v[56:59], v[160:163]
    ds_read2_b32 v[100:101], v241 offset0:128 offset1:129
    v_mfma_f32_16x16x32_bf16 v[164:167], v[40:43], v[60:63], v[164:167]
    ds_read2_b32 v[102:103], v241 offset0:130 offset1:131
    v_mfma_f32_16x16x32_bf16 v[168:171], v[40:43], v[64:67], v[168:171]
    ds_read_b128 v[136:139], v244 offset:2048
    v_mfma_f32_16x16x32_bf16 v[172:175], v[40:43], v[68:71], v[172:175]
    ds_read2_b32 v[104:105], v242 offset0:0 offset1:1
    v_mfma_f32_16x16x32_bf16 v[164:167], v[24:27], v[76:79], v[164:167]
    ds_read2_b32 v[106:107], v242 offset0:2 offset1:3
    v_mfma_f32_16x16x32_bf16 v[168:171], v[28:31], v[76:79], v[168:171]
    ds_read_b128 v[140:143], v244 offset:2560
    v_mfma_f32_16x16x32_bf16 v[172:175], v[32:35], v[76:79], v[172:175]
    ds_read2_b32 v[108:109], v242 offset0:128 offset1:129
    v_mfma_f32_16x16x32_bf16 v[164:167], v[44:47], v[56:59], v[164:167]
    ds_read2_b32 v[110:111], v242 offset0:130 offset1:131
    v_mfma_f32_16x16x32_bf16 v[168:171], v[44:47], v[60:63], v[168:171]
    ds_read_b128 v[144:147], v244 offset:3072
    v_mfma_f32_16x16x32_bf16 v[172:175], v[44:47], v[64:67], v[172:175]
    ds_read2_b32 v[112:113], v243 offset0:0 offset1:1
    v_mfma_f32_16x16x32_bf16 v[168:171], v[24:27], v[80:83], v[168:171]
    ds_read2_b32 v[114:115], v243 offset0:2 offset1:3
    v_mfma_f32_16x16x32_bf16 v[172:175], v[28:31], v[80:83], v[172:175]
    ds_read_b128 v[148:151], v244 offset:3584
    v_mfma_f32_16x16x32_bf16 v[168:171], v[48:51], v[56:59], v[168:171]
    ds_read2_b32 v[116:117], v243 offset0:128 offset1:129
    v_mfma_f32_16x16x32_bf16 v[172:175], v[48:51], v[60:63], v[172:175]
    ds_read2_b32 v[118:119], v243 offset0:130 offset1:131
    v_mfma_f32_16x16x32_bf16 v[172:175], v[24:27], v[84:87], v[172:175]
    v_add_u32 v240, s54, v240
    v_add_u32 v241, s54, v241
    v_add_u32 v242, s54, v242
    v_add_u32 v243, s54, v243
    v_add_u32 v244, s55, v244
    v_mfma_f32_16x16x32_bf16 v[172:175], v[52:55], v[56:59], v[172:175]
    s_waitcnt lgkmcnt(0)
    v_mfma_f32_16x16x32_bf16 v[160:163], v[96:99], v[128:131], v[160:163]
    ds_read_b128 v[56:59], v244 offset:0
    v_mfma_f32_16x16x32_bf16 v[160:163], v[92:95], v[132:135], v[160:163]
    ds_read2_b32 v[24:25], v240 offset0:0 offset1:1
    v_mfma_f32_16x16x32_bf16 v[164:167], v[96:99], v[132:135], v[164:167]
    ds_read2_b32 v[26:27], v240 offset0:2 offset1:3
    v_mfma_f32_16x16x32_bf16 v[160:163], v[100:103], v[124:127], v[160:163]
    ds_read_b128 v[60:63], v244 offset:512
    v_mfma_f32_16x16x32_bf16 v[164:167], v[100:103], v[128:131], v[164:167]
    ds_read2_b32 v[28:29], v240 offset0:128 offset1:129
    s_cmp_eq_u32 s75, 0
    s_cbranch_scc1 L_A_bs1
    s_waitcnt lgkmcnt(5)
    s_cmp_eq_u32 s70, 2
    s_cbranch_scc1 L_A_st2a
    buffer_store_dwordx3 v[212:214], v248, s[64:67], s73 offen sc1
    s_branch L_A_st2b
L_A_st2a:
    buffer_store_dwordx2 v[212:213], v248, s[64:67], s73 offen sc1
L_A_st2b:
    s_add_u32 s73, s73, 147456
    s_sub_u32 s72, s72, 1
    s_min_u32 s75, s72, 1
    ds_read_b32 v212, v235 offset:0
    ds_read_b32 v213, v235 offset:8192
    ds_read_b32 v214, v235 offset:16384
    v_add_u32 v235, 128, v235
L_A_bs1:
    v_mfma_f32_16x16x32_bf16 v[168:171], v[100:103], v[132:135], v[168:171]
    ds_read2_b32 v[30:31], v240 offset0:130 offset1:131
    v_mfma_f32_16x16x32_bf16 v[160:163], v[88:91], v[136:139], v[160:163]
    ds_read_b128 v[64:67], v244 offset:1024
    v_mfma_f32_16x16x32_bf16 v[164:167], v[92:95], v[136:139], v[164:167]
    ds_read2_b32 v[32:33], v241 offset0:0 offset1:1
    v_mfma_f32_16x16x32_bf16 v[168:171], v[96:99], v[136:139], v[168:171]
    ds_read2_b32 v[34:35], v241 offset0:2 offset1:3
    v_mfma_f32_16x16x32_bf16 v[172:175], v[100:103], v[136:139], v[172:175]
    ds_read_b128 v[68:71], v244 offset:1536
    v_mfma_f32_16x16x32_bf16 v[160:163], v[104:107], v[120:123], v[160:163]
    ds_read2_b32 v[36:37], v241 offset0:128 offset1:129
    v_mfma_f32_16x16x32_bf16 v[164:167], v[104:107], v[124:127], v[164:167]
    ds_read2_b32 v[38:39], v241 offset0:130 offset1:131
    v_mfma_f32_16x16x32_bf16 v[168:171], v[104:107], v[128:131], v[168:171]
    ds_read_b128 v[72:75], v244 offset:2048
    v_mfma_f32_16x16x32_bf16 v[172:175], v[104:107], v[132:135], v[172:175]
    ds_read2_b32 v[40:41], v242 offset0:0 offset1:1
    v_mfma_f32_16x16x32_bf16 v[164:167], v[88:91], v[140:143], v[164:167]
    ds_read2_b32 v[42:43], v242 offset0:2 offset1:3
    v_mfma_f32_16x16x32_bf16 v[168:171], v[92:95], v[140:143], v[168:171]
    ds_read_b128 v[76:79], v244 offset:2560
    v_mfma_f32_16x16x32_bf16 v[172:175], v[96:99], v[140:143], v[172:175]
    ds_read2_b32 v[44:45], v242 offset0:128 offset1:129
    v_mfma_f32_16x16x32_bf16 v[164:167], v[108:111], v[120:123], v[164:167]
    ds_read2_b32 v[46:47], v242 offset0:130 offset1:131
    v_mfma_f32_16x16x32_bf16 v[168:171], v[108:111], v[124:127], v[168:171]
    ds_read_b128 v[80:83], v244 offset:3072
    v_mfma_f32_16x16x32_bf16 v[172:175], v[108:111], v[128:131], v[172:175]
    ds_read2_b32 v[48:49], v243 offset0:0 offset1:1
    v_mfma_f32_16x16x32_bf16 v[168:171], v[88:91], v[144:147], v[168:171]
    ds_read2_b32 v[50:51], v243 offset0:2 offset1:3
    v_mfma_f32_16x16x32_bf16 v[172:175], v[92:95], v[144:147], v[172:175]
    ds_read_b128 v[84:87], v244 offset:3584
    v_mfma_f32_16x16x32_bf16 v[168:171], v[112:115], v[120:123], v[168:171]
    ds_read2_b32 v[52:53], v243 offset0:128 offset1:129
    v_mfma_f32_16x16x32_bf16 v[172:175], v[112:115], v[124:127], v[172:175]
    ds_read2_b32 v[54:55], v243 offset0:130 offset1:131
    v_mfma_f32_16x16x32_bf16 v[172:175], v[88:91], v[148:151], v[172:175]
    v_add_u32 v240, 64, v240
    v_add_u32 v241, 64, v241
    v_add_u32 v242, 64, v242
    v_add_u32 v243, 64, v243
    v_subrev_u32 v244, 64, v244
    v_mfma_f32_16x16x32_bf16 v[172:175], v[116:119], v[120:123], v[172:175]
    s_waitcnt lgkmcnt(0)
    s_add_u32 s7, s7, 1
    s_cmp_ge_u32 s3, 6
    s_cbranch_scc1 L_A1_hend
    s_cmp_eq_u32 s7, s74
    s_cbranch_scc1 L_A1_fin
    s_cmp_lg_u32 s7, 1
    s_cbranch_scc1 L_A1_x
    s_cmp_eq_u32 s72, 0
    s_cbranch_scc1 L_A1_x
L_A_yw:
    ds_read_b32 v23, v233 offset:16
    s_waitcnt lgkmcnt(0)
    v_cmp_gt_u32 vcc, s71, v23
    s_cbranch_vccnz L_A_yw
    ds_read_b32 v212, v235 offset:0
    ds_read_b32 v213, v235 offset:8192
    ds_read_b32 v214, v235 offset:16384
    v_add_u32 v235, 128, v235
    s_mov_b32 s75, 1
L_A1_x:
    s_add_u32 s6, s7, 1
    s_cmp_lg_u32 s6, s74
    s_cbranch_scc1 L_A1_conv
    s_cmp_eq_u32 s74, 4
    s_cbranch_scc1 L_A1_conv
L_A1_w1:
    ds_read_b32 v23, v19 offset:8
    s_waitcnt lgkmcnt(0)
    v_cmp_ge_u32 vcc, s79, v23
    s_cbranch_vccnz L_A1_w1
    ds_read_b128 v[196:199], v245 offset:0
    ds_read_b128 v[200:203], v245 offset:1024
    ds_read_b128 v[204:207], v245 offset:2048
    ds_read_b128 v[208:211], v245 offset:3072
    s_branch L_A1_conv
L_A1_fin:
    v_pk_add_f32 v[196:197], v[196:197], v[160:161]
    v_pk_add_f32 v[198:199], v[198:199], v[162:163]
    v_pk_add_f32 v[200:201], v[200:201], v[164:165]
    v_pk_add_f32 v[202:203], v[202:203], v[166:167]
    v_pk_add_f32 v[204:205], v[204:205], v[168:169]
    v_pk_add_f32 v[206:207], v[206:207], v[170:171]
    v_pk_add_f32 v[208:209], v[208:209], v[172:173]
    v_pk_add_f32 v[210:211], v[210:211], v[174:175]
    ds_write_b128 v246, v[196:199] offset:0
    ds_write_b128 v246, v[200:203] offset:1024
    ds_write_b128 v246, v[204:207] offset:2048
    ds_write_b128 v246, v[208:211] offset:3072
    s_branch L_A1_end
L_A_hlp:
    s_setprio 1
    s_branch L_A1_go
L_A1_hend:
    s_mov_b32 s54, 64
    s_mov_b32 s55, -64
    s_cmp_eq_u32 s7, 2
    s_cbranch_scc1 L_A1_conv
    ds_write_b128 v245, v[160:163] offset:0
    ds_write_b128 v245, v[164:167] offset:1024
    ds_write_b128 v245, v[168:171] offset:2048
    ds_write_b128 v245, v[172:175] offset:3072
    v_mov_b32 v23, 1
    s_mov_b64 exec, 1
    ds_add_u32 v19, v23 offset:8
    s_mov_b64 exec, -1
    v_add_u32 v245, 32768, v245
    s_cmp_eq_u32 s70, 2
    s_cselect_b32 s6, 3, s7
    s_cmp_eq_u32 s6, 1
    s_cbranch_scc1 L_A1_init
L_A_yw2:
    ds_read_b32 v23, v233 offset:16
    s_waitcnt lgkmcnt(0)
    v_cmp_gt_u32 vcc, s71, v23
    s_cbranch_vccnz L_A_yw2
    ds_read_b32 v24, v235 offset:0
    ds_read_b32 v25, v235 offset:8192
    ds_read_b32 v26, v235 offset:16384
    ds_read_b32 v28, v235 offset:128
    ds_read_b32 v29, v235 offset:8320
    ds_read_b32 v30, v235 offset:16512
    ds_read_b32 v32, v235 offset:256
    ds_read_b32 v33, v235 offset:8448
    ds_read_b32 v34, v235 offset:16640
    ds_read_b32 v36, v235 offset:384
    ds_read_b32 v37, v235 offset:8576
    ds_read_b32 v38, v235 offset:16768
    ds_read_b32 v40, v235 offset:512
    ds_read_b32 v41, v235 offset:8704
    ds_read_b32 v42, v235 offset:16896
    ds_read_b32 v44, v235 offset:640
    ds_read_b32 v45, v235 offset:8832
    ds_read_b32 v46, v235 offset:17024
    s_waitcnt lgkmcnt(0)
    s_cmp_eq_u32 s70, 2
    s_cbranch_scc1 L_A_st3a
    buffer_store_dwordx3 v[24:26], v248, s[64:67], s73 offen sc1
    s_branch L_A_st3b
L_A_st3a:
    buffer_store_dwordx2 v[24:25], v248, s[64:67], s73 offen sc1
L_A_st3b:
    s_add_u32 s73, s73, 147456
    s_cmp_eq_u32 s70, 2
    s_cbranch_scc1 L_A_st4a
    buffer_store_dwordx3 v[28:30], v248, s[64:67], s73 offen sc1
    s_branch L_A_st4b
L_A_st4a:
    buffer_store_dwordx2 v[28:29], v248, s[64:67], s73 offen sc1
L_A_st4b:
    s_add_u32 s73, s73, 147456
    s_cmp_eq_u32 s70, 2
    s_cbranch_scc1 L_A_st5a
    buffer_store_dwordx3 v[32:34], v248, s[64:67], s73 offen sc1
    s_branch L_A_st5b
L_A_st5a:
    buffer_store_dwordx2 v[32:33], v248, s[64:67], s73 offen sc1
L_A_st5b:
    s_add_u32 s73, s73, 147456
    s_cmp_eq_u32 s70, 2
    s_cbranch_scc1 L_A_st6a
    buffer_store_dwordx3 v[36:38], v248, s[64:67], s73 offen sc1
    s_branch L_A_st6b
L_A_st6a:
    buffer_store_dwordx2 v[36:37], v248, s[64:67], s73 offen sc1
L_A_st6b:
    s_add_u32 s73, s73, 147456
    s_cmp_eq_u32 s70, 2
    s_cbranch_scc1 L_A_st7a
    buffer_store_dwordx3 v[40:42], v248, s[64:67], s73 offen sc1
    s_branch L_A_st7b
L_A_st7a:
    buffer_store_dwordx2 v[40:41], v248, s[64:67], s73 offen sc1
L_A_st7b:
    s_add_u32 s73, s73, 147456
    s_cmp_eq_u32 s70, 2
    s_cbranch_scc1 L_A_st8a
    buffer_store_dwordx3 v[44:46], v248, s[64:67], s73 offen sc1
    s_branch L_A_st8b
L_A_st8a:
    buffer_store_dwordx2 v[44:45], v248, s[64:67], s73 offen sc1
L_A_st8b:
    s_add_u32 s73, s73, 147456
L_A1_end:
    s_waitcnt lgkmcnt(0)
    s_barrier
    ds_read_b32 v212, v247 offset:0
    ds_read_b32 v213, v247 offset:8768
    ds_read_b32 v214, v247 offset:17536
    ds_read_b32 v216, v247 offset:128
    ds_read_b32 v217, v247 offset:8896
    ds_read_b32 v218, v247 offset:17664
    ds_read_b32 v220, v247 offset:256
    ds_read_b32 v221, v247 offset:9024
    ds_read_b32 v222, v247 offset:17792
    ds_read_b32 v224, v247 offset:384
    ds_read_b32 v225, v247 offset:9152
    ds_read_b32 v226, v247 offset:17920
    s_waitcnt lgkmcnt(9)
    s_cmp_eq_u32 s70, 2
    s_cbranch_scc1 L_A_st9a
    buffer_store_dwordx3 v[212:214], v248, s[64:67], s8 offen
    s_branch L_A_st9b
L_A_st9a:
    buffer_store_dwordx2 v[212:213], v248, s[64:67], s8 offen
L_A_st9b:
    s_add_u32 s8, s8, 147456
    s_waitcnt lgkmcnt(6)
    s_cmp_eq_u32 s70, 2
    s_cbranch_scc1 L_A_st10a
    buffer_store_dwordx3 v[216:218], v248, s[64:67], s8 offen
    s_branch L_A_st10b
L_A_st10a:
    buffer_store_dwordx2 v[216:217], v248, s[64:67], s8 offen
L_A_st10b:
    s_add_u32 s8, s8, 147456
    s_waitcnt lgkmcnt(3)
    s_cmp_eq_u32 s70, 2
    s_cbranch_scc1 L_A_st11a
    buffer_store_dwordx3 v[220:222], v248, s[64:67], s8 offen
    s_branch L_A_st11b
L_A_st11a:
    buffer_store_dwordx2 v[220:221], v248, s[64:67], s8 offen
L_A_st11b:
    s_add_u32 s8, s8, 147456
    s_waitcnt lgkmcnt(0)
    s_cmp_eq_u32 s70, 2
    s_cbranch_scc1 L_A_st12a
    buffer_store_dwordx3 v[224:226], v248, s[64:67], s8 offen
    s_branch L_A_st12b
L_A_st12a:
    buffer_store_dwordx2 v[224:225], v248, s[64:67], s8 offen
L_A_st12b:
    s_add_u32 s8, s8, 147456
    s_endpgm
L_end:
    s_endpgm
.section .rodata,"a"
.p2align 6
.amdhsa_kernel concat_heads__ssm_conv_s4d__ssm_conv_s5__prompt_kernel
  .amdhsa_next_free_vgpr 256
  .amdhsa_next_free_sgpr 102
  .amdhsa_accum_offset 256
  .amdhsa_group_segment_fixed_size 0
  .amdhsa_kernarg_size 152
  .amdhsa_user_sgpr_count 2
  .amdhsa_user_sgpr_kernarg_segment_ptr 1
  .amdhsa_system_sgpr_workgroup_id_x 1
.end_amdhsa_kernel
```
